```python
import torch

def _softmax(x, axis=-1):
    return torch.softmax(x, dim=axis)
def _gelu(x):
    return torch.nn.functional.gelu(x, approximate="tanh")
def _silu(x):
    return torch.nn.functional.silu(x)
def _sigmoid(x):
    return torch.sigmoid(x)
def _layernorm(x, axis=-1, eps=1e-5):
    m = x.mean(dim=axis, keepdim=True)
    v = x.var(dim=axis, keepdim=True, unbiased=False)
    return (x - m) / torch.sqrt(v + eps)
def _scatter_add(tgt, idx, src, axis=0):
    return tgt.clone().index_add_(axis, idx, src)
def _segment_sum(src, seg, n):
    out = torch.zeros((n,) + src.shape[1:], dtype=src.dtype)
    return out.index_add_(0, seg, src)
def _pad(x, pw):
    flat = tuple(v for pair in reversed(pw) for v in pair)
    return torch.nn.functional.pad(x, flat)

kernel_name = 'standalone__mha_block_cached__near_ridge'

def setup_inputs():

    _w = (lambda a: (lambda t: t.to(torch.bfloat16) if t.is_floating_point() else t)(torch.as_tensor(a)))
    B, Sq, D = 16, 48, 640
    H, Sk, Dh = 32, 48, 128
    return {
        "x": _w((lambda *s: torch.randn(*s, dtype=torch.bfloat16) * 0.8)(B, Sq, D)),
        "k_cache": _w((lambda *s: torch.randn(*s, dtype=torch.bfloat16) * 0.8)(B, H, Sk, Dh)),
        "v_cache": _w((lambda *s: torch.randn(*s, dtype=torch.bfloat16) * 0.05)(B, H, Sk, Dh)),
        "wq": _w((lambda *s: torch.randn(*s, dtype=torch.bfloat16) * 0.8)(D, H * Dh) * (D ** -0.5)),
        "wo": _w((lambda *s: torch.randn(*s, dtype=torch.bfloat16) * 0.05)(H * Dh, D) * ((H * Dh) ** -0.5)),
    }

def reference(x, k_cache, v_cache, wq, wo):
    B, Sq, D = x.shape
    H, Dh = 32, 128
    q = (lambda x, *d: x.permute(*d))((x @ wq).reshape(B, Sq, H, Dh), 0, 2, 1, 3)
    scores = torch.einsum("bhqd,bhkd->bhqk", q, k_cache) * (Dh ** -0.5)
    p = _softmax(scores, axis=-1)
    o = torch.einsum("bhqk,bhkd->bhqd", p, v_cache)
    return (lambda x, *d: x.permute(*d))(o, 0, 2, 1, 3).reshape(B, Sq, H * Dh) @ wo
```

```asm
; @launch grid=(256,1,1) block=(512,1,1) lds=163840
.amdgcn_target "amdgcn-amd-amdhsa--gfx950"
.text
.globl standalone__mha_block_cached__near_ridge_kernel
.p2align 8
.type standalone__mha_block_cached__near_ridge_kernel,@function
standalone__mha_block_cached__near_ridge_kernel:
    s_cmp_ge_u32 s2, 256
    s_cbranch_scc1 L_end
    s_load_dwordx16 s[36:51], s[0:1], 0
    v_lshrrev_b32 v2, 6, v0
    v_and_b32 v1, 63, v0
    s_and_b32 s6, s2, 7
    v_readfirstlane_b32 s3, v2
    s_lshr_b32 s7, s2, 3
    s_and_b32 s7, s7, 3
    s_lshr_b32 s5, s2, 5
    s_lshl_b32 s4, s6, 2
    s_add_u32 s4, s4, s7
    v_lshrrev_b32 v2, 4, v1
    v_lshlrev_b32 v3, 4, v1
    s_and_b32 s58, s3, 1
    s_cmp_lt_u32 s3, 4
    s_cbranch_scc1 L_compute
    s_setprio 2
    s_and_b32 s59, s3, 3
    s_add_u32 s53, s7, s5
    s_mul_i32 s54, s53, 43
    s_lshr_b32 s54, s54, 7
    s_mul_i32 s54, s54, 3
    s_sub_u32 s53, s53, s54
    s_mul_i32 s53, s53, 7
    s_lshr_b32 s53, s53, 1
    s_add_u32 s53, s53, s6
    s_cmp_ge_u32 s53, 10
    s_cselect_b32 s54, 10, 0
    s_sub_u32 s53, s53, s54
    s_cmp_ge_u32 s53, 10
    s_cselect_b32 s54, 10, 0
    s_sub_u32 s53, s53, s54
    v_lshrrev_b32 v20, 3, v1
    v_and_b32 v21, 7, v1
    v_xor_b32 v21, v21, v2
    s_mul_i32 s54, s5, 96
    s_mul_i32 s55, s59, 24
    s_add_u32 s54, s54, s55
    v_add_u32 v20, s54, v20
    v_mul_u32_u24 v20, 1280, v20
    s_lshl_b32 s55, s58, 2
    v_xor_b32 v22, s55, v21
    v_xor_b32 v23, 4, v22
    v_lshl_add_u32 v4, v22, 4, v20
    v_lshl_add_u32 v5, v23, 4, v20
    v_add_u32 v5, 9216, v5
    v_add_u32 v6, 18432, v4
    v_and_b32 v20, 15, v1
    v_lshlrev_b32 v21, 1, v2
    v_xor_b32 v20, v20, v21
    s_lshl_b32 s54, s59, 4
    v_add_u32 v21, s54, v2
    v_lshlrev_b32 v21, 13, v21
    s_lshl_b32 s54, s4, 8
    v_add_u32 v21, s54, v21
    v_lshl_add_u32 v7, v20, 4, v21
    v_add_u32 v8, 31744, v7
    v_xor_b32 v20, 8, v20
    v_lshl_add_u32 v9, v20, 4, v21
    v_add_u32 v9, 63488, v9
    v_add_u32 v10, 31744, v9
    s_mul_i32 s56, s59, 3072
    s_lshl_b32 s57, s59, 12
    s_add_u32 s57, s57, 12288
    s_waitcnt lgkmcnt(0)
    s_mov_b32 s8, s36
    s_and_b32 s9, s37, 0xffff
    s_mov_b32 s10, 983040
    s_mov_b32 s11, 0x20000
    s_mov_b32 s20, s42
    s_and_b32 s21, s43, 0xffff
    s_mov_b32 s22, 5242880
    s_mov_b32 s23, 0x20000
    s_lshl_b32 s54, s53, 7
    s_add_u32 m0, s56, 0
    s_lshl_b32 s55, s53, 19
    buffer_load_dwordx4 v4, s[8:11], s54 offen offset:0 lds
    buffer_load_dwordx4 v5, s[8:11], s54 offen offset:1024 lds
    buffer_load_dwordx4 v6, s[8:11], s54 offen offset:2048 lds
    s_add_u32 m0, s57, 0
    s_add_u32 s53, s53, 1
    buffer_load_dwordx4 v7, s[20:23], s55 offen offset:0 lds
    buffer_load_dwordx4 v8, s[20:23], s55 offen offset:1024 lds
    buffer_load_dwordx4 v9, s[20:23], s55 offen offset:2048 lds
    buffer_load_dwordx4 v10, s[20:23], s55 offen offset:3072 lds
    s_cmp_ge_u32 s53, 10
    s_cselect_b32 s53, 0, s53
    s_lshl_b32 s54, s53, 7
    s_add_u32 m0, s56, 32768
    s_lshl_b32 s55, s53, 19
    buffer_load_dwordx4 v4, s[8:11], s54 offen offset:0 lds
    buffer_load_dwordx4 v5, s[8:11], s54 offen offset:1024 lds
    buffer_load_dwordx4 v6, s[8:11], s54 offen offset:2048 lds
    s_add_u32 m0, s57, 32768
    s_add_u32 s53, s53, 1
    buffer_load_dwordx4 v7, s[20:23], s55 offen offset:0 lds
    buffer_load_dwordx4 v8, s[20:23], s55 offen offset:1024 lds
    buffer_load_dwordx4 v9, s[20:23], s55 offen offset:2048 lds
    buffer_load_dwordx4 v10, s[20:23], s55 offen offset:3072 lds
    s_cmp_ge_u32 s53, 10
    s_cselect_b32 s53, 0, s53
    s_mov_b32 s12, s38
    s_and_b32 s13, s39, 0xffff
    s_mov_b32 s14, 6291456
    s_mov_b32 s15, 0x20000
    s_mov_b32 s16, s40
    s_and_b32 s17, s41, 0xffff
    s_mov_b32 s18, 6291456
    s_mov_b32 s19, 0x20000
    s_mov_b32 s32, s50
    s_and_b32 s33, s51, 0xffff
    s_mov_b32 s34, 268435456
    s_mov_b32 s35, 0x20000
    s_mov_b32 s24, s44
    s_and_b32 s25, s45, 0xffff
    s_mov_b32 s26, 5242880
    s_mov_b32 s27, 0x20000
    s_mov_b32 s28, s46
    s_and_b32 s29, s47, 0xffff
    s_mov_b32 s30, 983040
    s_mov_b32 s31, 0x20000
    s_lshr_b32 s55, s59, 1
    s_lshl_b32 s54, s5, 1
    s_add_u32 s54, s54, s55
    s_lshl_b32 s54, s54, 5
    s_add_u32 s54, s54, s4
    s_mul_i32 s54, s54, 12288
    s_mul_i32 s55, s58, 6144
    s_add_u32 s66, s54, s55
    s_mul_i32 s65, s59, 6144
    v_lshlrev_b32 v20, 4, v2
    v_xor_b32 v20, v3, v20
    s_lshl_b32 s54, s58, 1
    s_add_u32 s54, s54, 0
    s_and_b32 s54, s54, 3
    s_lshl_b32 s54, s54, 6
    v_xor_b32 v11, s54, v20
    s_lshl_b32 s54, s58, 1
    s_add_u32 s54, s54, 1
    s_and_b32 s54, s54, 3
    s_lshl_b32 s54, s54, 6
    v_xor_b32 v12, s54, v20
    s_lshl_b32 s54, s58, 1
    s_add_u32 s54, s54, 2
    s_and_b32 s54, s54, 3
    s_lshl_b32 s54, s54, 6
    v_xor_b32 v13, s54, v20
    s_lshl_b32 s54, s58, 1
    s_add_u32 s54, s54, 3
    s_and_b32 s54, s54, 3
    s_lshl_b32 s54, s54, 6
    v_xor_b32 v14, s54, v20
    s_lshl_b32 s54, s5, 7
    s_load_dword s52, s[50:51], s54
    s_cmp_ge_u32 s3, 3
    s_cselect_b32 s60, 1, 0
    s_mul_i32 s54, s60, 3
    s_sub_u32 s61, s3, s54
    v_and_b32 v16, 15, v1
    v_lshrrev_b32 v17, 1, v2
    v_xor_b32 v17, v17, v16
    v_lshlrev_b32 v17, 4, v17
    v_lshl_add_u32 v17, v16, 8, v17
    v_and_b32 v18, 1, v2
    v_lshl_add_u32 v17, v18, 3, v17
    s_mul_i32 s54, s60, 12288
    s_add_u32 s54, s54, 98304
    v_add_u32 v141, s54, v17
    s_lshl_b32 s54, s5, 3
    s_add_u32 s54, s54, s6
    s_lshl_b32 s55, s54, 7
    s_add_u32 s68, s55, 4096
    s_lshl_b32 s55, s54, 8
    s_add_u32 s62, s55, 16384
    s_lshl_b32 s55, s60, 7
    s_add_u32 s64, s62, s55
    s_mul_i32 s54, s54, 36864
    s_add_u32 s45, s54, 1048576
    s_mul_i32 s54, s7, 9216
    s_add_u32 s54, s54, s45
    s_mul_i32 s55, s3, 1536
    s_add_u32 s63, s54, s55
    s_add_u32 s36, s7, s5
    s_and_b32 s36, s36, 3
    s_lshr_b32 s37, s5, 2
    s_add_u32 s55, s55, 65536
    v_add_u32 v80, s55, v3
    v_lshlrev_b32 v82, 3, v1
    v_add_u32 v81, s55, v82
    s_lshl_b32 s55, s3, 12
    s_add_u32 s55, s55, 73728
    v_add_u32 v85, s55, v3
    s_mul_i32 s54, s7, 3
    s_add_u32 s54, s54, s61
    s_lshl_b32 s54, s54, 2
    v_mov_b32 v83, s54
    s_lshl_b32 s54, s5, 2
    s_add_u32 s54, s54, s36
    s_mul_i32 s54, s54, 262144
    s_add_u32 s43, s54, 8388608
    v_add_u32 v20, 0, v1
    v_mul_u32_u24 v21, 52429, v20
    v_lshrrev_b32 v21, 20, v21
    v_mul_u32_u24 v23, 20, v21
    v_sub_u32 v20, v20, v23
    v_bfe_u32 v23, v21, 3, 1
    v_lshlrev_b32 v23, 1, v23
    v_xor_b32 v20, v23, v20
    v_mul_u32_u24 v21, 1280, v21
    v_lshl_add_u32 v144, v20, 4, v21
    v_add_u32 v20, 64, v1
    v_mul_u32_u24 v21, 52429, v20
    v_lshrrev_b32 v21, 20, v21
    v_mul_u32_u24 v23, 20, v21
    v_sub_u32 v20, v20, v23
    v_bfe_u32 v23, v21, 3, 1
    v_lshlrev_b32 v23, 1, v23
    v_xor_b32 v20, v23, v20
    v_mul_u32_u24 v21, 1280, v21
    v_lshl_add_u32 v145, v20, 4, v21
    v_subrev_u32 v145, 1024, v145
    v_add_u32 v20, 128, v1
    v_mul_u32_u24 v21, 52429, v20
    v_lshrrev_b32 v21, 20, v21
    v_mul_u32_u24 v23, 20, v21
    v_sub_u32 v20, v20, v23
    v_bfe_u32 v23, v21, 3, 1
    v_lshlrev_b32 v23, 1, v23
    v_xor_b32 v20, v23, v20
    v_mul_u32_u24 v21, 1280, v21
    v_lshl_add_u32 v146, v20, 4, v21
    v_subrev_u32 v146, 2048, v146
    v_add_u32 v20, 192, v1
    v_mul_u32_u24 v21, 52429, v20
    v_lshrrev_b32 v21, 20, v21
    v_mul_u32_u24 v23, 20, v21
    v_sub_u32 v20, v20, v23
    v_bfe_u32 v23, v21, 3, 1
    v_lshlrev_b32 v23, 1, v23
    v_xor_b32 v20, v23, v20
    v_mul_u32_u24 v21, 1280, v21
    v_lshl_add_u32 v147, v20, 4, v21
    v_subrev_u32 v147, 3072, v147
    v_add_u32 v20, 256, v1
    v_mul_u32_u24 v21, 52429, v20
    v_lshrrev_b32 v21, 20, v21
    v_mul_u32_u24 v23, 20, v21
    v_sub_u32 v20, v20, v23
    v_bfe_u32 v23, v21, 3, 1
    v_lshlrev_b32 v23, 1, v23
    v_xor_b32 v20, v23, v20
    v_mul_u32_u24 v21, 1280, v21
    v_lshl_add_u32 v148, v20, 4, v21
    v_lshrrev_b32 v20, 3, v1
    v_lshlrev_b32 v20, 8, v20
    v_and_b32 v21, 7, v1
    v_xor_b32 v21, v21, v2
    v_lshl_add_u32 v149, v21, 4, v20
    v_xor_b32 v21, 4, v21
    v_lshl_add_u32 v150, v21, 4, v20
    v_add_u32 v150, 1024, v150
    v_add_u32 v151, 2048, v149
    v_add_u32 v152, 2048, v150
    s_mul_i32 s40, s6, 655360
    s_mul_i32 s54, s36, 320
    s_add_u32 s40, s40, s54
    s_mul_i32 s54, s58, 20480
    s_add_u32 s40, s40, s54
    s_mul_i32 s41, s58, 5120
    s_add_u32 s41, s41, 12288
    s_lshl_b32 s54, s5, 1
    s_add_u32 s54, s54, s58
    s_lshl_b32 s54, s54, 5
    s_lshl_b32 s55, s6, 2
    s_add_u32 s54, s54, s55
    s_mul_i32 s38, s54, 12288
    s_mul_i32 s39, s58, 6144
    s_lshl_b32 s54, s2, 2
    s_add_u32 s54, s54, s59
    s_lshl_b32 s54, s54, 7
    s_add_u32 s69, s54, 131072
    s_load_dword s42, s[50:51], s69
    s_add_u32 s54, s69, 64
    s_load_dword s42, s[50:51], s54
    s_lshl_b32 s54, s58, 7
    s_add_u32 s62, s62, s54
    s_load_dword s42, s[50:51], s62
    s_add_u32 s54, s62, 64
    s_load_dword s42, s[50:51], s54
    s_waitcnt vmcnt(7)
    s_barrier
    s_lshl_b32 s54, s53, 7
    s_add_u32 m0, s56, 65536
    s_lshl_b32 s55, s53, 19
    buffer_load_dwordx4 v4, s[8:11], s54 offen offset:0 lds
    buffer_load_dwordx4 v5, s[8:11], s54 offen offset:1024 lds
    buffer_load_dwordx4 v6, s[8:11], s54 offen offset:2048 lds
    s_add_u32 m0, s57, 65536
    s_add_u32 s53, s53, 1
    buffer_load_dwordx4 v7, s[20:23], s55 offen offset:0 lds
    buffer_load_dwordx4 v8, s[20:23], s55 offen offset:1024 lds
    buffer_load_dwordx4 v9, s[20:23], s55 offen offset:2048 lds
    buffer_load_dwordx4 v10, s[20:23], s55 offen offset:3072 lds
    s_cmp_ge_u32 s53, 10
    s_cselect_b32 s53, 0, s53
    s_waitcnt vmcnt(7)
    s_barrier
    s_lshl_b32 s54, s53, 7
    s_add_u32 m0, s56, 0
    s_lshl_b32 s55, s53, 19
    buffer_load_dwordx4 v4, s[8:11], s54 offen offset:0 lds
    buffer_load_dwordx4 v5, s[8:11], s54 offen offset:1024 lds
    buffer_load_dwordx4 v6, s[8:11], s54 offen offset:2048 lds
    s_add_u32 m0, s57, 0
    s_add_u32 s53, s53, 1
    buffer_load_dwordx4 v7, s[20:23], s55 offen offset:0 lds
    buffer_load_dwordx4 v8, s[20:23], s55 offen offset:1024 lds
    buffer_load_dwordx4 v9, s[20:23], s55 offen offset:2048 lds
    buffer_load_dwordx4 v10, s[20:23], s55 offen offset:3072 lds
    s_cmp_ge_u32 s53, 10
    s_cselect_b32 s53, 0, s53
    s_waitcnt lgkmcnt(0)
    s_mul_i32 s52, s52, 0x41C64E6D
    s_add_u32 s52, s52, 0x3039
    v_mov_b32 v84, s52
    s_getreg_b32 s54, hwreg(HW_REG_XCC_ID, 0, 4)
    s_lshl_b32 s54, s54, 8
    s_or_b32 s54, s54, 0x5a
    s_xor_b32 s67, s52, s54
    s_waitcnt vmcnt(7)
    s_barrier
    s_lshl_b32 s54, s53, 7
    s_add_u32 m0, s56, 32768
    s_lshl_b32 s55, s53, 19
    buffer_load_dwordx4 v4, s[8:11], s54 offen offset:0 lds
    buffer_load_dwordx4 v5, s[8:11], s54 offen offset:1024 lds
    buffer_load_dwordx4 v6, s[8:11], s54 offen offset:2048 lds
    s_add_u32 m0, s57, 32768
    s_add_u32 s53, s53, 1
    buffer_load_dwordx4 v7, s[20:23], s55 offen offset:0 lds
    buffer_load_dwordx4 v8, s[20:23], s55 offen offset:1024 lds
    buffer_load_dwordx4 v9, s[20:23], s55 offen offset:2048 lds
    buffer_load_dwordx4 v10, s[20:23], s55 offen offset:3072 lds
    s_cmp_ge_u32 s53, 10
    s_cselect_b32 s53, 0, s53
    s_add_u32 m0, s65, 98304
    s_add_u32 s54, s66, 0
    buffer_load_dwordx4 v11, s[12:15], s54 offen offset:0 lds
    buffer_load_dwordx4 v12, s[12:15], s54 offen offset:1024 lds
    buffer_load_dwordx4 v13, s[12:15], s54 offen offset:2048 lds
    buffer_load_dwordx4 v14, s[12:15], s54 offen offset:3072 lds
    s_add_u32 m0, s65, 102400
    s_add_u32 s54, s66, 4096
    buffer_load_dwordx4 v11, s[12:15], s54 offen offset:0 lds
    buffer_load_dwordx4 v12, s[12:15], s54 offen offset:1024 lds
    s_waitcnt vmcnt(13)
    s_barrier
    s_lshl_b32 s54, s53, 7
    s_add_u32 m0, s56, 65536
    s_lshl_b32 s55, s53, 19
    buffer_load_dwordx4 v4, s[8:11], s54 offen offset:0 lds
    buffer_load_dwordx4 v5, s[8:11], s54 offen offset:1024 lds
    buffer_load_dwordx4 v6, s[8:11], s54 offen offset:2048 lds
    s_add_u32 m0, s57, 65536
    s_add_u32 s53, s53, 1
    buffer_load_dwordx4 v7, s[20:23], s55 offen offset:0 lds
    buffer_load_dwordx4 v8, s[20:23], s55 offen offset:1024 lds
    buffer_load_dwordx4 v9, s[20:23], s55 offen offset:2048 lds
    buffer_load_dwordx4 v10, s[20:23], s55 offen offset:3072 lds
    s_cmp_ge_u32 s53, 10
    s_cselect_b32 s53, 0, s53
    s_waitcnt vmcnt(13)
    s_barrier
    s_lshl_b32 s54, s53, 7
    s_add_u32 m0, s56, 0
    s_lshl_b32 s55, s53, 19
    buffer_load_dwordx4 v4, s[8:11], s54 offen offset:0 lds
    buffer_load_dwordx4 v5, s[8:11], s54 offen offset:1024 lds
    buffer_load_dwordx4 v6, s[8:11], s54 offen offset:2048 lds
    s_add_u32 m0, s57, 0
    s_add_u32 s53, s53, 1
    buffer_load_dwordx4 v7, s[20:23], s55 offen offset:0 lds
    buffer_load_dwordx4 v8, s[20:23], s55 offen offset:1024 lds
    buffer_load_dwordx4 v9, s[20:23], s55 offen offset:2048 lds
    buffer_load_dwordx4 v10, s[20:23], s55 offen offset:3072 lds
    s_cmp_ge_u32 s53, 10
    s_cselect_b32 s53, 0, s53
    s_waitcnt vmcnt(7)
    s_barrier
    s_lshl_b32 s54, s53, 7
    s_add_u32 m0, s56, 32768
    s_lshl_b32 s55, s53, 19
    buffer_load_dwordx4 v4, s[8:11], s54 offen offset:0 lds
    buffer_load_dwordx4 v5, s[8:11], s54 offen offset:1024 lds
    buffer_load_dwordx4 v6, s[8:11], s54 offen offset:2048 lds
    s_add_u32 m0, s57, 32768
    s_add_u32 s53, s53, 1
    buffer_load_dwordx4 v7, s[20:23], s55 offen offset:0 lds
    buffer_load_dwordx4 v8, s[20:23], s55 offen offset:1024 lds
    buffer_load_dwordx4 v9, s[20:23], s55 offen offset:2048 lds
    buffer_load_dwordx4 v10, s[20:23], s55 offen offset:3072 lds
    s_cmp_ge_u32 s53, 10
    s_cselect_b32 s53, 0, s53
    s_cmp_ge_u32 s3, 6
    s_cbranch_scc1 L_nok_1
    v_xor_b32 v142, 0, v141
    ds_read_b64 v[92:93], v142 offset:0
    ds_read_b64 v[108:109], v142 offset:4096
    ds_read_b64 v[124:125], v142 offset:8192
    v_xor_b32 v142, 128, v141
    ds_read_b64 v[100:101], v142 offset:0
    ds_read_b64 v[116:117], v142 offset:4096
    ds_read_b64 v[132:133], v142 offset:8192
L_nok_1:
    s_waitcnt vmcnt(7)
    s_barrier
    s_lshl_b32 s54, s53, 7
    s_add_u32 m0, s56, 65536
    s_lshl_b32 s55, s53, 19
    buffer_load_dwordx4 v4, s[8:11], s54 offen offset:0 lds
    buffer_load_dwordx4 v5, s[8:11], s54 offen offset:1024 lds
    buffer_load_dwordx4 v6, s[8:11], s54 offen offset:2048 lds
    s_add_u32 m0, s57, 65536
    s_add_u32 s53, s53, 1
    buffer_load_dwordx4 v7, s[20:23], s55 offen offset:0 lds
    buffer_load_dwordx4 v8, s[20:23], s55 offen offset:1024 lds
    buffer_load_dwordx4 v9, s[20:23], s55 offen offset:2048 lds
    buffer_load_dwordx4 v10, s[20:23], s55 offen offset:3072 lds
    s_cmp_ge_u32 s53, 10
    s_cselect_b32 s53, 0, s53
    s_cmp_ge_u32 s3, 6
    s_cbranch_scc1 L_nok_2
    v_xor_b32 v143, 32, v141
    ds_read_b64 v[94:95], v143 offset:0
    ds_read_b64 v[110:111], v143 offset:4096
    ds_read_b64 v[126:127], v143 offset:8192
    v_xor_b32 v143, 160, v141
    ds_read_b64 v[102:103], v143 offset:0
    ds_read_b64 v[118:119], v143 offset:4096
    ds_read_b64 v[134:135], v143 offset:8192
L_nok_2:
    s_waitcnt vmcnt(7)
    s_barrier
    s_lshl_b32 s54, s53, 7
    s_add_u32 m0, s56, 0
    s_lshl_b32 s55, s53, 19
    buffer_load_dwordx4 v4, s[8:11], s54 offen offset:0 lds
    buffer_load_dwordx4 v5, s[8:11], s54 offen offset:1024 lds
    buffer_load_dwordx4 v6, s[8:11], s54 offen offset:2048 lds
    s_add_u32 m0, s57, 0
    s_add_u32 s53, s53, 1
    buffer_load_dwordx4 v7, s[20:23], s55 offen offset:0 lds
    buffer_load_dwordx4 v8, s[20:23], s55 offen offset:1024 lds
    buffer_load_dwordx4 v9, s[20:23], s55 offen offset:2048 lds
    buffer_load_dwordx4 v10, s[20:23], s55 offen offset:3072 lds
    s_cmp_ge_u32 s53, 10
    s_cselect_b32 s53, 0, s53
    s_cmp_ge_u32 s3, 6
    s_cbranch_scc1 L_nok_3
    v_xor_b32 v142, 64, v141
    ds_read_b64 v[96:97], v142 offset:0
    ds_read_b64 v[112:113], v142 offset:4096
    ds_read_b64 v[128:129], v142 offset:8192
    v_xor_b32 v142, 192, v141
    ds_read_b64 v[104:105], v142 offset:0
    ds_read_b64 v[120:121], v142 offset:4096
    ds_read_b64 v[136:137], v142 offset:8192
L_nok_3:
    s_waitcnt vmcnt(7)
    s_cmp_ge_u32 s3, 6
    s_cbranch_scc1 L_q_loader
    s_barrier
    v_and_b32 v20, 3, v1
    v_lshlrev_b32 v20, 2, v20
    buffer_load_dword v140, v20, s[32:35], s68 offen sc1
    v_xor_b32 v143, 96, v141
    ds_read_b64 v[98:99], v143 offset:0
    ds_read_b64 v[114:115], v143 offset:4096
    ds_read_b64 v[130:131], v143 offset:8192
    v_xor_b32 v143, 224, v141
    ds_read_b64 v[106:107], v143 offset:0
    ds_read_b64 v[122:123], v143 offset:4096
    ds_read_b64 v[138:139], v143 offset:8192
    s_waitcnt vmcnt(1) lgkmcnt(0)
    s_barrier
    s_branch L_attn
L_q_loader:
    s_barrier
    s_add_u32 s54, s7, 0
    s_and_b32 s54, s54, 3
    s_xor_b32 s55, s37, 0
    s_mul_i32 s56, s54, 12288
    s_lshl_b32 s57, s55, 7
    s_add_u32 s56, s56, s57
    s_add_u32 s56, s56, s38
    s_lshl_b32 s54, s54, 1
    s_add_u32 s54, s54, s55
    s_mul_i32 s54, s54, 81920
    s_add_u32 s54, s54, s40
    s_add_u32 m0, s39, 131072
    s_nop 0
    buffer_load_dwordx4 v149, s[16:19], s56 offen offset:0 lds
    buffer_load_dwordx4 v150, s[16:19], s56 offen offset:1024 lds
    buffer_load_dwordx4 v151, s[16:19], s56 offen offset:2048 lds
    buffer_load_dwordx4 v152, s[16:19], s56 offen offset:3072 lds
    s_add_u32 m0, s39, 135168
    s_add_u32 s56, s56, 8192
    buffer_load_dwordx4 v149, s[16:19], s56 offen offset:0 lds
    buffer_load_dwordx4 v150, s[16:19], s56 offen offset:1024 lds
    s_add_u32 m0, s41, 131072
    s_nop 0
    buffer_load_dwordx4 v144, s[24:27], s54 offen offset:0 lds
    buffer_load_dwordx4 v145, s[24:27], s54 offen offset:1024 lds
    buffer_load_dwordx4 v146, s[24:27], s54 offen offset:2048 lds
    s_waitcnt vmcnt(9)
    s_barrier
    s_setprio 1
    buffer_load_dwordx4 v147, s[24:27], s54 offen offset:3072 lds
    s_add_u32 m0, s41, 135168
    s_nop 0
    buffer_load_dwordx4 v148, s[24:27], s54 offen lds
    s_add_u32 m0, s41, 141312
    s_add_u32 s54, s54, 40960
    buffer_load_dwordx4 v144, s[24:27], s54 offen offset:0 lds
    buffer_load_dwordx4 v145, s[24:27], s54 offen offset:1024 lds
    buffer_load_dwordx4 v146, s[24:27], s54 offen offset:2048 lds
    buffer_load_dwordx4 v147, s[24:27], s54 offen offset:3072 lds
    s_add_u32 m0, s41, 145408
    s_nop 0
    buffer_load_dwordx4 v148, s[24:27], s54 offen lds
    s_add_u32 s54, s7, 0
    s_and_b32 s54, s54, 3
    s_xor_b32 s55, s37, 1
    s_mul_i32 s56, s54, 12288
    s_lshl_b32 s57, s55, 7
    s_add_u32 s56, s56, s57
    s_add_u32 s56, s56, s38
    s_lshl_b32 s54, s54, 1
    s_add_u32 s54, s54, s55
    s_mul_i32 s54, s54, 81920
    s_add_u32 s54, s54, s40
    s_add_u32 m0, s39, 32768
    s_nop 0
    buffer_load_dwordx4 v149, s[16:19], s56 offen offset:0 lds
    buffer_load_dwordx4 v150, s[16:19], s56 offen offset:1024 lds
    buffer_load_dwordx4 v151, s[16:19], s56 offen offset:2048 lds
    buffer_load_dwordx4 v152, s[16:19], s56 offen offset:3072 lds
    s_add_u32 m0, s39, 36864
    s_add_u32 s56, s56, 8192
    buffer_load_dwordx4 v149, s[16:19], s56 offen offset:0 lds
    buffer_load_dwordx4 v150, s[16:19], s56 offen offset:1024 lds
    s_add_u32 m0, s41, 32768
    s_nop 0
    buffer_load_dwordx4 v144, s[24:27], s54 offen offset:0 lds
    buffer_load_dwordx4 v145, s[24:27], s54 offen offset:1024 lds
    buffer_load_dwordx4 v146, s[24:27], s54 offen offset:2048 lds
    buffer_load_dwordx4 v147, s[24:27], s54 offen offset:3072 lds
    s_add_u32 m0, s41, 36864
    s_nop 0
    buffer_load_dwordx4 v148, s[24:27], s54 offen lds
    s_add_u32 m0, s41, 43008
    s_add_u32 s54, s54, 40960
    buffer_load_dwordx4 v144, s[24:27], s54 offen offset:0 lds
    buffer_load_dwordx4 v145, s[24:27], s54 offen offset:1024 lds
    s_barrier
    buffer_load_dwordx4 v146, s[24:27], s54 offen offset:2048 lds
    buffer_load_dwordx4 v147, s[24:27], s54 offen offset:3072 lds
    s_add_u32 m0, s41, 47104
    s_nop 0
    buffer_load_dwordx4 v148, s[24:27], s54 offen lds
    s_add_u32 s54, s7, 1
    s_and_b32 s54, s54, 3
    s_xor_b32 s55, s37, 0
    s_mul_i32 s56, s54, 12288
    s_lshl_b32 s57, s55, 7
    s_add_u32 s56, s56, s57
    s_add_u32 s56, s56, s38
    s_lshl_b32 s54, s54, 1
    s_add_u32 s54, s54, s55
    s_mul_i32 s54, s54, 81920
    s_add_u32 s54, s54, s40
    s_add_u32 m0, s39, 98304
    s_nop 0
    buffer_load_dwordx4 v149, s[16:19], s56 offen offset:0 lds
    buffer_load_dwordx4 v150, s[16:19], s56 offen offset:1024 lds
    buffer_load_dwordx4 v151, s[16:19], s56 offen offset:2048 lds
    buffer_load_dwordx4 v152, s[16:19], s56 offen offset:3072 lds
    s_add_u32 m0, s39, 102400
    s_add_u32 s56, s56, 8192
    buffer_load_dwordx4 v149, s[16:19], s56 offen offset:0 lds
    s_waitcnt vmcnt(21)
    s_barrier
    buffer_load_dwordx4 v150, s[16:19], s56 offen offset:1024 lds
    s_add_u32 m0, s41, 98304
    s_nop 0
    buffer_load_dwordx4 v144, s[24:27], s54 offen offset:0 lds
    buffer_load_dwordx4 v145, s[24:27], s54 offen offset:1024 lds
    buffer_load_dwordx4 v146, s[24:27], s54 offen offset:2048 lds
    buffer_load_dwordx4 v147, s[24:27], s54 offen offset:3072 lds
    s_add_u32 m0, s41, 102400
    s_nop 0
    buffer_load_dwordx4 v148, s[24:27], s54 offen lds
    s_add_u32 m0, s41, 108544
    s_add_u32 s54, s54, 40960
    buffer_load_dwordx4 v144, s[24:27], s54 offen offset:0 lds
    buffer_load_dwordx4 v145, s[24:27], s54 offen offset:1024 lds
    buffer_load_dwordx4 v146, s[24:27], s54 offen offset:2048 lds
    buffer_load_dwordx4 v147, s[24:27], s54 offen offset:3072 lds
    s_add_u32 m0, s41, 112640
    s_nop 0
    buffer_load_dwordx4 v148, s[24:27], s54 offen lds
    s_add_u32 s54, s7, 1
    s_and_b32 s54, s54, 3
    s_xor_b32 s55, s37, 1
    s_mul_i32 s56, s54, 12288
    s_lshl_b32 s57, s55, 7
    s_add_u32 s56, s56, s57
    s_add_u32 s56, s56, s38
    s_lshl_b32 s54, s54, 1
    s_add_u32 s54, s54, s55
    s_mul_i32 s54, s54, 81920
    s_add_u32 s54, s54, s40
    s_add_u32 m0, s39, 0
    s_nop 0
    buffer_load_dwordx4 v149, s[16:19], s56 offen offset:0 lds
    s_waitcnt vmcnt(17)
    s_barrier
    buffer_load_dwordx4 v150, s[16:19], s56 offen offset:1024 lds
    buffer_load_dwordx4 v151, s[16:19], s56 offen offset:2048 lds
    buffer_load_dwordx4 v152, s[16:19], s56 offen offset:3072 lds
    s_add_u32 m0, s39, 4096
    s_add_u32 s56, s56, 8192
    buffer_load_dwordx4 v149, s[16:19], s56 offen offset:0 lds
    buffer_load_dwordx4 v150, s[16:19], s56 offen offset:1024 lds
    s_add_u32 m0, s41, 0
    s_nop 0
    buffer_load_dwordx4 v144, s[24:27], s54 offen offset:0 lds
    buffer_load_dwordx4 v145, s[24:27], s54 offen offset:1024 lds
    buffer_load_dwordx4 v146, s[24:27], s54 offen offset:2048 lds
    buffer_load_dwordx4 v147, s[24:27], s54 offen offset:3072 lds
    s_add_u32 m0, s41, 4096
    s_nop 0
    buffer_load_dwordx4 v148, s[24:27], s54 offen lds
    s_add_u32 m0, s41, 10240
    s_add_u32 s54, s54, 40960
    buffer_load_dwordx4 v144, s[24:27], s54 offen offset:0 lds
    buffer_load_dwordx4 v145, s[24:27], s54 offen offset:1024 lds
    buffer_load_dwordx4 v146, s[24:27], s54 offen offset:2048 lds
    buffer_load_dwordx4 v147, s[24:27], s54 offen offset:3072 lds
    s_add_u32 m0, s41, 14336
    s_nop 0
    buffer_load_dwordx4 v148, s[24:27], s54 offen lds
    s_add_u32 s54, s7, 2
    s_and_b32 s54, s54, 3
    s_xor_b32 s55, s37, 0
    s_mul_i32 s56, s54, 12288
    s_lshl_b32 s57, s55, 7
    s_add_u32 s56, s56, s57
    s_add_u32 s56, s56, s38
    s_lshl_b32 s54, s54, 1
    s_add_u32 s54, s54, s55
    s_mul_i32 s54, s54, 81920
    s_add_u32 s54, s54, s40
    s_add_u32 m0, s39, 131072
    s_nop 0
    buffer_load_dwordx4 v149, s[16:19], s56 offen offset:0 lds
    s_waitcnt vmcnt(17)
    s_barrier
    buffer_load_dwordx4 v150, s[16:19], s56 offen offset:1024 lds
    buffer_load_dwordx4 v151, s[16:19], s56 offen offset:2048 lds
    buffer_load_dwordx4 v152, s[16:19], s56 offen offset:3072 lds
    s_add_u32 m0, s39, 135168
    s_add_u32 s56, s56, 8192
    buffer_load_dwordx4 v149, s[16:19], s56 offen offset:0 lds
    buffer_load_dwordx4 v150, s[16:19], s56 offen offset:1024 lds
    s_add_u32 m0, s41, 131072
    s_nop 0
    buffer_load_dwordx4 v144, s[24:27], s54 offen offset:0 lds
    buffer_load_dwordx4 v145, s[24:27], s54 offen offset:1024 lds
    buffer_load_dwordx4 v146, s[24:27], s54 offen offset:2048 lds
    buffer_load_dwordx4 v147, s[24:27], s54 offen offset:3072 lds
    s_add_u32 m0, s41, 135168
    s_nop 0
    buffer_load_dwordx4 v148, s[24:27], s54 offen lds
    s_add_u32 m0, s41, 141312
    s_add_u32 s54, s54, 40960
    buffer_load_dwordx4 v144, s[24:27], s54 offen offset:0 lds
    buffer_load_dwordx4 v145, s[24:27], s54 offen offset:1024 lds
    buffer_load_dwordx4 v146, s[24:27], s54 offen offset:2048 lds
    buffer_load_dwordx4 v147, s[24:27], s54 offen offset:3072 lds
    s_add_u32 m0, s41, 145408
    s_nop 0
    buffer_load_dwordx4 v148, s[24:27], s54 offen lds
    s_add_u32 s54, s7, 2
    s_and_b32 s54, s54, 3
    s_xor_b32 s55, s37, 1
    s_mul_i32 s56, s54, 12288
    s_lshl_b32 s57, s55, 7
    s_add_u32 s56, s56, s57
    s_add_u32 s56, s56, s38
    s_lshl_b32 s54, s54, 1
    s_add_u32 s54, s54, s55
    s_mul_i32 s54, s54, 81920
    s_add_u32 s54, s54, s40
    s_add_u32 m0, s39, 32768
    s_nop 0
    buffer_load_dwordx4 v149, s[16:19], s56 offen offset:0 lds
    s_waitcnt vmcnt(17)
    s_barrier
    buffer_load_dwordx4 v150, s[16:19], s56 offen offset:1024 lds
    buffer_load_dwordx4 v151, s[16:19], s56 offen offset:2048 lds
    buffer_load_dwordx4 v152, s[16:19], s56 offen offset:3072 lds
    s_add_u32 m0, s39, 36864
    s_add_u32 s56, s56, 8192
    buffer_load_dwordx4 v149, s[16:19], s56 offen offset:0 lds
    buffer_load_dwordx4 v150, s[16:19], s56 offen offset:1024 lds
    s_add_u32 m0, s41, 32768
    s_nop 0
    buffer_load_dwordx4 v144, s[24:27], s54 offen offset:0 lds
    buffer_load_dwordx4 v145, s[24:27], s54 offen offset:1024 lds
    buffer_load_dwordx4 v146, s[24:27], s54 offen offset:2048 lds
    buffer_load_dwordx4 v147, s[24:27], s54 offen offset:3072 lds
    s_add_u32 m0, s41, 36864
    s_nop 0
    buffer_load_dwordx4 v148, s[24:27], s54 offen lds
    s_add_u32 m0, s41, 43008
    s_add_u32 s54, s54, 40960
    buffer_load_dwordx4 v144, s[24:27], s54 offen offset:0 lds
    buffer_load_dwordx4 v145, s[24:27], s54 offen offset:1024 lds
    buffer_load_dwordx4 v146, s[24:27], s54 offen offset:2048 lds
    buffer_load_dwordx4 v147, s[24:27], s54 offen offset:3072 lds
    s_add_u32 m0, s41, 47104
    s_nop 0
    buffer_load_dwordx4 v148, s[24:27], s54 offen lds
    s_add_u32 s54, s7, 3
    s_and_b32 s54, s54, 3
    s_xor_b32 s55, s37, 0
    s_mul_i32 s56, s54, 12288
    s_lshl_b32 s57, s55, 7
    s_add_u32 s56, s56, s57
    s_add_u32 s56, s56, s38
    s_lshl_b32 s54, s54, 1
    s_add_u32 s54, s54, s55
    s_mul_i32 s54, s54, 81920
    s_add_u32 s54, s54, s40
    s_add_u32 m0, s39, 98304
    s_nop 0
    buffer_load_dwordx4 v149, s[16:19], s56 offen offset:0 lds
    s_waitcnt vmcnt(17)
    s_barrier
    buffer_load_dwordx4 v150, s[16:19], s56 offen offset:1024 lds
    buffer_load_dwordx4 v151, s[16:19], s56 offen offset:2048 lds
    buffer_load_dwordx4 v152, s[16:19], s56 offen offset:3072 lds
    s_add_u32 m0, s39, 102400
    s_add_u32 s56, s56, 8192
    buffer_load_dwordx4 v149, s[16:19], s56 offen offset:0 lds
    buffer_load_dwordx4 v150, s[16:19], s56 offen offset:1024 lds
    s_add_u32 m0, s41, 98304
    s_nop 0
    buffer_load_dwordx4 v144, s[24:27], s54 offen offset:0 lds
    buffer_load_dwordx4 v145, s[24:27], s54 offen offset:1024 lds
    buffer_load_dwordx4 v146, s[24:27], s54 offen offset:2048 lds
    buffer_load_dwordx4 v147, s[24:27], s54 offen offset:3072 lds
    s_add_u32 m0, s41, 102400
    s_nop 0
    buffer_load_dwordx4 v148, s[24:27], s54 offen lds
    s_add_u32 m0, s41, 108544
    s_add_u32 s54, s54, 40960
    buffer_load_dwordx4 v144, s[24:27], s54 offen offset:0 lds
    buffer_load_dwordx4 v145, s[24:27], s54 offen offset:1024 lds
    buffer_load_dwordx4 v146, s[24:27], s54 offen offset:2048 lds
    buffer_load_dwordx4 v147, s[24:27], s54 offen offset:3072 lds
    s_add_u32 m0, s41, 112640
    s_nop 0
    buffer_load_dwordx4 v148, s[24:27], s54 offen lds
    s_add_u32 s54, s7, 3
    s_and_b32 s54, s54, 3
    s_xor_b32 s55, s37, 1
    s_mul_i32 s56, s54, 12288
    s_lshl_b32 s57, s55, 7
    s_add_u32 s56, s56, s57
    s_add_u32 s56, s56, s38
    s_lshl_b32 s54, s54, 1
    s_add_u32 s54, s54, s55
    s_mul_i32 s54, s54, 81920
    s_add_u32 s54, s54, s40
    s_add_u32 m0, s39, 0
    s_nop 0
    buffer_load_dwordx4 v149, s[16:19], s56 offen offset:0 lds
    s_waitcnt vmcnt(17)
    s_barrier
    buffer_load_dwordx4 v150, s[16:19], s56 offen offset:1024 lds
    buffer_load_dwordx4 v151, s[16:19], s56 offen offset:2048 lds
    buffer_load_dwordx4 v152, s[16:19], s56 offen offset:3072 lds
    s_add_u32 m0, s39, 4096
    s_add_u32 s56, s56, 8192
    buffer_load_dwordx4 v149, s[16:19], s56 offen offset:0 lds
    buffer_load_dwordx4 v150, s[16:19], s56 offen offset:1024 lds
    s_add_u32 m0, s41, 0
    s_nop 0
    buffer_load_dwordx4 v144, s[24:27], s54 offen offset:0 lds
    buffer_load_dwordx4 v145, s[24:27], s54 offen offset:1024 lds
    buffer_load_dwordx4 v146, s[24:27], s54 offen offset:2048 lds
    buffer_load_dwordx4 v147, s[24:27], s54 offen offset:3072 lds
    s_add_u32 m0, s41, 4096
    s_nop 0
    buffer_load_dwordx4 v148, s[24:27], s54 offen lds
    s_add_u32 m0, s41, 10240
    s_add_u32 s54, s54, 40960
    buffer_load_dwordx4 v144, s[24:27], s54 offen offset:0 lds
    buffer_load_dwordx4 v145, s[24:27], s54 offen offset:1024 lds
    buffer_load_dwordx4 v146, s[24:27], s54 offen offset:2048 lds
    buffer_load_dwordx4 v147, s[24:27], s54 offen offset:3072 lds
    s_add_u32 m0, s41, 14336
    s_nop 0
    buffer_load_dwordx4 v148, s[24:27], s54 offen lds
    s_waitcnt vmcnt(16)
    s_barrier
    s_waitcnt vmcnt(0)
    s_barrier
L_reducer:
    s_setprio 0
    v_and_b32 v22, 7, v1
    v_lshlrev_b32 v22, 2, v22
    s_waitcnt lgkmcnt(0)
    s_lshr_b32 s60, s6, 2
    s_and_b32 s61, s6, 3
    s_lshr_b32 s40, s59, 1
    v_bfe_u32 v7, v1, 2, 2
    v_and_b32 v8, 3, v1
    s_lshl_b32 s54, s58, 2
    v_add_u32 v9, s54, v2
    v_lshlrev_b32 v4, 10, v9
    v_lshl_add_u32 v4, v8, 6, v4
    v_lshl_add_u32 v4, v7, 4, v4
    s_lshl_b32 s54, s60, 1
    s_add_u32 s54, s54, s40
    s_lshl_b32 s54, s54, 13
    s_lshl_b32 s55, s61, 8
    s_add_u32 s54, s54, s55
    s_add_u32 s43, s43, s54
    v_lshlrev_b32 v9, 1, v9
    v_add_u32 v10, 1, v9
    v_mul_u32_u24 v13, 43, v9
    v_lshrrev_b32 v13, 7, v13
    v_mul_u32_u24 v14, 3, v13
    v_sub_u32 v14, v9, v14
    v_lshl_add_u32 v14, v14, 4, v7
    v_mul_u32_u24 v14, 1280, v14
    v_lshl_add_u32 v5, v13, 5, v14
    v_lshl_add_u32 v5, v8, 3, v5
    v_mul_u32_u24 v13, 43, v10
    v_lshrrev_b32 v13, 7, v13
    v_mul_u32_u24 v14, 3, v13
    v_sub_u32 v14, v10, v14
    v_lshl_add_u32 v14, v14, 4, v7
    v_mul_u32_u24 v14, 1280, v14
    v_lshl_add_u32 v6, v13, 5, v14
    v_lshl_add_u32 v6, v8, 3, v6
    v_cmp_gt_u32 s[38:39], 15, v10
    s_mul_i32 s54, s5, 96
    s_mul_i32 s55, s60, 48
    s_add_u32 s54, s54, s55
    s_lshl_b32 s55, s61, 2
    s_add_u32 s54, s54, s55
    s_mul_i32 s54, s54, 1280
    s_mul_i32 s55, s36, 320
    s_add_u32 s54, s54, s55
    s_mul_i32 s55, s40, 160
    s_add_u32 s60, s54, s55
    s_add_u32 s8, s43, 0
    s_add_u32 s9, s43, 32768
    s_add_u32 s10, s43, 65536
    s_add_u32 s11, s43, 98304
    s_add_u32 s12, s43, 131072
    s_add_u32 s13, s43, 163840
    s_add_u32 s14, s43, 196608
    s_add_u32 s15, s43, 229376
    s_mov_b32 s42, 0xffff0000
    s_mov_b32 s53, 0
    s_mov_b32 s61, 0
    s_mov_b32 s41, 0
    s_barrier
L_poll2:
    buffer_load_dword v23, v22, s[32:35], s69 offen sc1
    s_add_u32 s53, s53, 1
    s_cmp_ge_u32 s53, 0x100000
    s_cbranch_scc1 L_got2
    s_waitcnt vmcnt(0)
    v_cmp_eq_u32 vcc, s52, v23
    s_and_b32 s54, vcc_lo, 0xff
    s_andn2_b32 s54, s54, s61
    s_cbranch_scc0 L_poll2
    s_or_b32 s61, s61, s54
    s_bitcmp1_b32 s54, 0
    s_cbranch_scc0 L_ns_4
    buffer_load_dwordx4 v[24:27], v4, s[32:35], s8 offen sc1
L_ns_4:
    s_bitcmp1_b32 s54, 1
    s_cbranch_scc0 L_ns_5
    buffer_load_dwordx4 v[28:31], v4, s[32:35], s9 offen sc1
L_ns_5:
    s_bitcmp1_b32 s54, 2
    s_cbranch_scc0 L_ns_6
    buffer_load_dwordx4 v[32:35], v4, s[32:35], s10 offen sc1
L_ns_6:
    s_bitcmp1_b32 s54, 3
    s_cbranch_scc0 L_ns_7
    buffer_load_dwordx4 v[36:39], v4, s[32:35], s11 offen sc1
L_ns_7:
    s_bitcmp1_b32 s54, 4
    s_cbranch_scc0 L_ns_8
    buffer_load_dwordx4 v[40:43], v4, s[32:35], s12 offen sc1
L_ns_8:
    s_bitcmp1_b32 s54, 5
    s_cbranch_scc0 L_ns_9
    buffer_load_dwordx4 v[44:47], v4, s[32:35], s13 offen sc1
L_ns_9:
    s_bitcmp1_b32 s54, 6
    s_cbranch_scc0 L_ns_10
    buffer_load_dwordx4 v[48:51], v4, s[32:35], s14 offen sc1
L_ns_10:
    s_bitcmp1_b32 s54, 7
    s_cbranch_scc0 L_ns_11
    buffer_load_dwordx4 v[52:55], v4, s[32:35], s15 offen sc1
L_ns_11:
    s_mov_b32 s55, s41
    s_mov_b32 s41, s54
L_unp:
    s_bitcmp1_b32 s55, 0
    s_cbranch_scc0 L_nu_12
    v_lshlrev_b32 v64, 16, v24
    v_and_b32 v65, s42, v24
    v_lshlrev_b32 v66, 16, v25
    v_and_b32 v67, s42, v25
    v_lshlrev_b32 v68, 16, v26
    v_and_b32 v69, s42, v26
    v_lshlrev_b32 v70, 16, v27
    v_and_b32 v71, s42, v27
L_nu_12:
    s_bitcmp1_b32 s55, 1
    s_cbranch_scc0 L_nu_13
    v_lshlrev_b32 v72, 16, v28
    v_and_b32 v73, s42, v28
    v_lshlrev_b32 v74, 16, v29
    v_and_b32 v75, s42, v29
    v_lshlrev_b32 v76, 16, v30
    v_and_b32 v77, s42, v30
    v_lshlrev_b32 v78, 16, v31
    v_and_b32 v79, s42, v31
L_nu_13:
    s_bitcmp1_b32 s55, 2
    s_cbranch_scc0 L_nu_14
    v_lshlrev_b32 v80, 16, v32
    v_and_b32 v81, s42, v32
    v_lshlrev_b32 v82, 16, v33
    v_and_b32 v83, s42, v33
    v_lshlrev_b32 v84, 16, v34
    v_and_b32 v85, s42, v34
    v_lshlrev_b32 v86, 16, v35
    v_and_b32 v87, s42, v35
L_nu_14:
    s_bitcmp1_b32 s55, 3
    s_cbranch_scc0 L_nu_15
    v_lshlrev_b32 v88, 16, v36
    v_and_b32 v89, s42, v36
    v_lshlrev_b32 v90, 16, v37
    v_and_b32 v91, s42, v37
    v_lshlrev_b32 v92, 16, v38
    v_and_b32 v93, s42, v38
    v_lshlrev_b32 v94, 16, v39
    v_and_b32 v95, s42, v39
L_nu_15:
    s_bitcmp1_b32 s55, 4
    s_cbranch_scc0 L_nu_16
    v_lshlrev_b32 v96, 16, v40
    v_and_b32 v97, s42, v40
    v_lshlrev_b32 v98, 16, v41
    v_and_b32 v99, s42, v41
    v_lshlrev_b32 v100, 16, v42
    v_and_b32 v101, s42, v42
    v_lshlrev_b32 v102, 16, v43
    v_and_b32 v103, s42, v43
L_nu_16:
    s_bitcmp1_b32 s55, 5
    s_cbranch_scc0 L_nu_17
    v_lshlrev_b32 v104, 16, v44
    v_and_b32 v105, s42, v44
    v_lshlrev_b32 v106, 16, v45
    v_and_b32 v107, s42, v45
    v_lshlrev_b32 v108, 16, v46
    v_and_b32 v109, s42, v46
    v_lshlrev_b32 v110, 16, v47
    v_and_b32 v111, s42, v47
L_nu_17:
    s_bitcmp1_b32 s55, 6
    s_cbranch_scc0 L_nu_18
    v_lshlrev_b32 v112, 16, v48
    v_and_b32 v113, s42, v48
    v_lshlrev_b32 v114, 16, v49
    v_and_b32 v115, s42, v49
    v_lshlrev_b32 v116, 16, v50
    v_and_b32 v117, s42, v50
    v_lshlrev_b32 v118, 16, v51
    v_and_b32 v119, s42, v51
L_nu_18:
    s_bitcmp1_b32 s55, 7
    s_cbranch_scc0 L_nu_19
    v_lshlrev_b32 v120, 16, v52
    v_and_b32 v121, s42, v52
    v_lshlrev_b32 v122, 16, v53
    v_and_b32 v123, s42, v53
    v_lshlrev_b32 v124, 16, v54
    v_and_b32 v125, s42, v54
    v_lshlrev_b32 v126, 16, v55
    v_and_b32 v127, s42, v55
L_nu_19:
    s_cmp_lg_u32 s61, 0xff
    s_cbranch_scc1 L_poll2
    s_cmp_eq_u32 s41, 0
    s_cbranch_scc1 L_got2
    s_waitcnt vmcnt(0)
    s_mov_b32 s55, s41
    s_mov_b32 s41, 0
    s_branch L_unp
L_got2:
    v_pk_add_f32 v[64:65], v[64:65], v[96:97]
    v_pk_add_f32 v[66:67], v[66:67], v[98:99]
    v_pk_add_f32 v[68:69], v[68:69], v[100:101]
    v_pk_add_f32 v[70:71], v[70:71], v[102:103]
    v_pk_add_f32 v[72:73], v[72:73], v[104:105]
    v_pk_add_f32 v[74:75], v[74:75], v[106:107]
    v_pk_add_f32 v[76:77], v[76:77], v[108:109]
    v_pk_add_f32 v[78:79], v[78:79], v[110:111]
    v_pk_add_f32 v[80:81], v[80:81], v[112:113]
    v_pk_add_f32 v[82:83], v[82:83], v[114:115]
    v_pk_add_f32 v[84:85], v[84:85], v[116:117]
    v_pk_add_f32 v[86:87], v[86:87], v[118:119]
    v_pk_add_f32 v[88:89], v[88:89], v[120:121]
    v_pk_add_f32 v[90:91], v[90:91], v[122:123]
    v_pk_add_f32 v[92:93], v[92:93], v[124:125]
    v_pk_add_f32 v[94:95], v[94:95], v[126:127]
    v_pk_add_f32 v[64:65], v[64:65], v[80:81]
    v_pk_add_f32 v[66:67], v[66:67], v[82:83]
    v_pk_add_f32 v[68:69], v[68:69], v[84:85]
    v_pk_add_f32 v[70:71], v[70:71], v[86:87]
    v_pk_add_f32 v[72:73], v[72:73], v[88:89]
    v_pk_add_f32 v[74:75], v[74:75], v[90:91]
    v_pk_add_f32 v[76:77], v[76:77], v[92:93]
    v_pk_add_f32 v[78:79], v[78:79], v[94:95]
    v_pk_add_f32 v[64:65], v[64:65], v[72:73]
    v_pk_add_f32 v[66:67], v[66:67], v[74:75]
    v_pk_add_f32 v[68:69], v[68:69], v[76:77]
    v_pk_add_f32 v[70:71], v[70:71], v[78:79]
    v_cvt_pk_bf16_f32 v80, v64, v65
    v_cvt_pk_bf16_f32 v81, v66, v67
    v_cvt_pk_bf16_f32 v82, v68, v69
    v_cvt_pk_bf16_f32 v83, v70, v71
    buffer_store_dwordx2 v[80:81], v5, s[28:31], s60 offen
    s_mov_b64 exec, s[38:39]
    buffer_store_dwordx2 v[82:83], v6, s[28:31], s60 offen
    s_mov_b64 exec, -1
    s_and_b32 s54, s2, 31
    s_or_b32 s54, s54, s59
    s_cmp_lg_u32 s54, 0
    s_cbranch_scc1 L_noep
    s_lshl_b32 s54, s5, 7
    v_mov_b32 v20, 0
    v_mov_b32 v21, s52
    s_mov_b64 exec, 1
    buffer_store_dword v21, v20, s[32:35], s54 offen sc1
    s_mov_b64 exec, -1
L_noep:
    s_endpgm
L_compute:
    s_getpc_b64 s[8:9]
L_pc:
    s_sub_u32 s8, s8, L_pc-standalone__mha_block_cached__near_ridge_kernel
    s_subb_u32 s9, s9, 0
    s_lshr_b32 s10, s2, 3
    s_lshl_b32 s10, s10, 2
    s_add_u32 s10, s10, s3
    s_lshl_b32 s10, s10, 6
    s_min_u32 s11, s10, L_end-standalone__mha_block_cached__near_ridge_kernel
    s_load_dword s12, s[8:9], s11
    s_add_u32 s10, s10, 8192
    s_min_u32 s11, s10, L_end-standalone__mha_block_cached__near_ridge_kernel
    s_load_dword s12, s[8:9], s11
    s_add_u32 s10, s10, 8192
    s_min_u32 s11, s10, L_end-standalone__mha_block_cached__near_ridge_kernel
    s_load_dword s12, s[8:9], s11
    s_add_u32 s10, s10, 8192
    s_lshr_b32 s59, s3, 1
    v_and_b32 v20, 15, v1
    v_lshrrev_b32 v21, 1, v20
    v_xor_b32 v21, v21, v2
    s_mul_i32 s54, s59, 48
    v_add_u32 v20, s54, v20
    v_lshlrev_b32 v20, 7, v20
    v_lshl_add_u32 v4, v21, 4, v20
    v_xor_b32 v5, 64, v4
    v_add_u32 v6, 0x10000, v4
    v_add_u32 v7, 0x10000, v5
    v_bfe_u32 v20, v1, 2, 2
    v_and_b32 v21, 1, v2
    v_lshl_or_b32 v21, v21, 2, v20
    s_lshl_b32 s54, s58, 2
    v_xor_b32 v21, s54, v21
    v_lshl_add_u32 v23, v2, 3, v20
    v_lshlrev_b32 v23, 8, v23
    v_and_b32 v22, 3, v1
    v_lshl_add_u32 v23, v22, 3, v23
    v_add_u32 v23, 12288, v23
    v_xor_b32 v22, 0, v21
    v_lshl_add_u32 v8, v22, 5, v23
    v_add_u32 v12, 0x10000, v8
    v_xor_b32 v22, 1, v21
    v_lshl_add_u32 v9, v22, 5, v23
    v_add_u32 v13, 0x10000, v9
    v_xor_b32 v22, 2, v21
    v_lshl_add_u32 v10, v22, 5, v23
    v_add_u32 v14, 0x10000, v10
    v_xor_b32 v22, 3, v21
    v_lshl_add_u32 v11, v22, 5, v23
    v_add_u32 v15, 0x10000, v11
    s_waitcnt lgkmcnt(0)
    s_mov_b32 s32, s50
    s_and_b32 s33, s51, 0xffff
    s_mov_b32 s34, 268435456
    s_mov_b32 s35, 0x20000
    s_mov_b32 s28, s46
    s_and_b32 s29, s47, 0xffff
    s_mov_b32 s30, 983040
    s_mov_b32 s31, 0x20000
    s_lshl_b32 s54, s5, 7
    s_load_dword s52, s[50:51], s54
    s_cmp_ge_u32 s3, 3
    s_cselect_b32 s60, 1, 0
    s_mul_i32 s54, s60, 3
    s_sub_u32 s61, s3, s54
    v_and_b32 v16, 15, v1
    v_lshrrev_b32 v17, 1, v2
    v_xor_b32 v17, v17, v16
    v_lshlrev_b32 v17, 4, v17
    v_lshl_add_u32 v17, v16, 8, v17
    v_and_b32 v18, 1, v2
    v_lshl_add_u32 v17, v18, 3, v17
    s_mul_i32 s54, s60, 12288
    s_add_u32 s54, s54, 98304
    v_add_u32 v141, s54, v17
    s_lshl_b32 s54, s5, 3
    s_add_u32 s54, s54, s6
    s_lshl_b32 s55, s54, 7
    s_add_u32 s68, s55, 4096
    s_lshl_b32 s55, s54, 8
    s_add_u32 s62, s55, 16384
    s_lshl_b32 s55, s60, 7
    s_add_u32 s64, s62, s55
    s_mul_i32 s54, s54, 36864
    s_add_u32 s45, s54, 1048576
    s_mul_i32 s54, s7, 9216
    s_add_u32 s54, s54, s45
    s_mul_i32 s55, s3, 1536
    s_add_u32 s63, s54, s55
    s_add_u32 s36, s7, s5
    s_and_b32 s36, s36, 3
    s_lshr_b32 s37, s5, 2
    s_add_u32 s55, s55, 65536
    v_add_u32 v80, s55, v3
    v_lshlrev_b32 v82, 3, v1
    v_add_u32 v81, s55, v82
    s_lshl_b32 s55, s3, 12
    s_add_u32 s55, s55, 73728
    v_add_u32 v85, s55, v3
    s_mul_i32 s54, s7, 3
    s_add_u32 s54, s54, s61
    s_lshl_b32 s54, s54, 2
    v_mov_b32 v83, s54
    s_lshl_b32 s54, s5, 2
    s_add_u32 s54, s54, s36
    s_mul_i32 s54, s54, 262144
    s_add_u32 s43, s54, 8388608
    v_bfe_u32 v19, v1, 2, 2
    v_lshl_add_u32 v19, v2, 3, v19
    v_mul_u32_u24 v19, 320, v19
    v_and_b32 v20, 3, v1
    v_lshl_add_u32 v19, v20, 3, v19
    s_mul_i32 s54, s58, 160
    s_add_u32 s54, s54, 12288
    v_add_u32 v19, s54, v19
    v_and_b32 v20, 1, v2
    v_lshlrev_b32 v20, 5, v20
    v_add_u32 v21, v19, v20
    v_sub_u32 v20, v19, v20
    s_cmp_eq_u32 s58, 0
    s_cselect_b64 vcc, -1, 0
    v_cndmask_b32 v87, v20, v21, vcc
    v_cndmask_b32 v88, v21, v20, vcc
    s_mul_i32 s54, s59, 12288
    s_lshl_b32 s55, s58, 11
    s_add_u32 s54, s54, s55
    s_add_u32 s54, s54, 73728
    v_add_u32 v86, s54, v3
    s_mul_i32 s54, s59, 4608
    s_add_u32 s44, s54, 65536
    s_mul_i32 s54, s6, 32768
    s_add_u32 s65, s43, s54
    s_lshl_b32 s54, s3, 13
    s_add_u32 s65, s65, s54
    s_add_u32 s66, s65, 4096
    s_andn2_b32 s55, s2, 7
    s_lshl_b32 s54, s59, 2
    s_add_u32 s55, s55, s54
    s_lshl_b32 s55, s55, 2
    s_lshl_b32 s54, s58, 1
    s_add_u32 s55, s55, s54
    s_lshl_b32 s55, s55, 7
    s_lshl_b32 s54, s6, 2
    s_add_u32 s55, s55, s54
    s_add_u32 s69, s55, 131072
    s_barrier
    ds_read_b64_tr_b16 a[0:1], v8 offset:0
    ds_read_b64_tr_b16 a[2:3], v8 offset:1024
    ds_read_b128 a[16:19], v4 offset:0
    ds_read_b128 a[20:23], v4 offset:2048
    ds_read_b128 a[24:27], v4 offset:4096
    ds_read_b64_tr_b16 a[4:5], v9 offset:0
    ds_read_b64_tr_b16 a[6:7], v9 offset:1024
    ds_read_b64_tr_b16 a[8:9], v10 offset:0
    ds_read_b64_tr_b16 a[10:11], v10 offset:1024
    ds_read_b64_tr_b16 a[12:13], v11 offset:0
    ds_read_b64_tr_b16 a[14:15], v11 offset:1024
    s_waitcnt lgkmcnt(8)
    v_mfma_f32_16x16x32_bf16 v[32:35], a[0:3], a[16:19], 0
    ds_read_b64_tr_b16 a[28:29], v8 offset:8192
    ds_read_b64_tr_b16 a[30:31], v8 offset:9216
    s_waitcnt lgkmcnt(9)
    v_mfma_f32_16x16x32_bf16 v[36:39], a[0:3], a[20:23], 0
    ds_read_b128 a[44:47], v5 offset:0
    ds_read_b128 a[48:51], v5 offset:2048
    s_waitcnt lgkmcnt(10)
    v_mfma_f32_16x16x32_bf16 v[40:43], a[0:3], a[24:27], 0
    ds_read_b128 a[52:55], v5 offset:4096
    ds_read_b64_tr_b16 a[32:33], v9 offset:8192
    s_waitcnt lgkmcnt(10)
    v_mfma_f32_16x16x32_bf16 v[44:47], a[4:7], a[16:19], 0
    ds_read_b64_tr_b16 a[34:35], v9 offset:9216
    ds_read_b64_tr_b16 a[36:37], v10 offset:8192
    v_mfma_f32_16x16x32_bf16 v[48:51], a[4:7], a[20:23], 0
    ds_read_b64_tr_b16 a[38:39], v10 offset:9216
    ds_read_b64_tr_b16 a[40:41], v11 offset:8192
    v_mfma_f32_16x16x32_bf16 v[52:55], a[4:7], a[24:27], 0
    ds_read_b64_tr_b16 a[42:43], v11 offset:9216
    s_waitcnt lgkmcnt(13)
    v_mfma_f32_16x16x32_bf16 v[56:59], a[8:11], a[16:19], 0
    v_mfma_f32_16x16x32_bf16 v[60:63], a[8:11], a[20:23], 0
    v_mfma_f32_16x16x32_bf16 v[64:67], a[8:11], a[24:27], 0
    s_waitcnt lgkmcnt(11)
    v_mfma_f32_16x16x32_bf16 v[68:71], a[12:15], a[16:19], 0
    v_mfma_f32_16x16x32_bf16 v[72:75], a[12:15], a[20:23], 0
    v_mfma_f32_16x16x32_bf16 v[76:79], a[12:15], a[24:27], 0
    s_waitcnt lgkmcnt(0)
    s_waitcnt lgkmcnt(0)
    s_mul_i32 s52, s52, 0x41C64E6D
    s_add_u32 s52, s52, 0x3039
    v_mov_b32 v84, s52
    s_getreg_b32 s54, hwreg(HW_REG_XCC_ID, 0, 4)
    s_lshl_b32 s54, s54, 8
    s_or_b32 s54, s54, 0x5a
    s_xor_b32 s67, s52, s54
    s_cmp_lg_u32 s3, 0
    s_cbranch_scc1 L_nohello
    s_lshl_b32 s54, s7, 2
    v_mov_b32 v20, s54
    v_mov_b32 v21, s67
    s_mov_b64 exec, 1
    buffer_store_dword v21, v20, s[32:35], s68 offen sc1
    s_mov_b64 exec, -1
L_nohello:
    s_barrier
    v_mfma_f32_16x16x32_bf16 v[32:35], a[28:31], a[44:47], v[32:35]
    ds_read_b64_tr_b16 a[0:1], v8 offset:32768
    ds_read_b64_tr_b16 a[2:3], v8 offset:33792
    v_mfma_f32_16x16x32_bf16 v[36:39], a[28:31], a[48:51], v[36:39]
    ds_read_b128 a[16:19], v4 offset:32768
    ds_read_b128 a[20:23], v4 offset:34816
    v_mfma_f32_16x16x32_bf16 v[40:43], a[28:31], a[52:55], v[40:43]
    ds_read_b128 a[24:27], v4 offset:36864
    ds_read_b64_tr_b16 a[4:5], v9 offset:32768
    v_mfma_f32_16x16x32_bf16 v[44:47], a[32:35], a[44:47], v[44:47]
    ds_read_b64_tr_b16 a[6:7], v9 offset:33792
    ds_read_b64_tr_b16 a[8:9], v10 offset:32768
    v_mfma_f32_16x16x32_bf16 v[48:51], a[32:35], a[48:51], v[48:51]
    ds_read_b64_tr_b16 a[10:11], v10 offset:33792
    ds_read_b64_tr_b16 a[12:13], v11 offset:32768
    v_mfma_f32_16x16x32_bf16 v[52:55], a[32:35], a[52:55], v[52:55]
    ds_read_b64_tr_b16 a[14:15], v11 offset:33792
    v_mfma_f32_16x16x32_bf16 v[56:59], a[36:39], a[44:47], v[56:59]
    v_mfma_f32_16x16x32_bf16 v[60:63], a[36:39], a[48:51], v[60:63]
    v_mfma_f32_16x16x32_bf16 v[64:67], a[36:39], a[52:55], v[64:67]
    v_mfma_f32_16x16x32_bf16 v[68:71], a[40:43], a[44:47], v[68:71]
    v_mfma_f32_16x16x32_bf16 v[72:75], a[40:43], a[48:51], v[72:75]
    v_mfma_f32_16x16x32_bf16 v[76:79], a[40:43], a[52:55], v[76:79]
    s_waitcnt lgkmcnt(8)
    v_mfma_f32_16x16x32_bf16 v[32:35], a[0:3], a[16:19], v[32:35]
    ds_read_b64_tr_b16 a[28:29], v8 offset:40960
    ds_read_b64_tr_b16 a[30:31], v8 offset:41984
    s_waitcnt lgkmcnt(9)
    v_mfma_f32_16x16x32_bf16 v[36:39], a[0:3], a[20:23], v[36:39]
    ds_read_b128 a[44:47], v5 offset:32768
    ds_read_b128 a[48:51], v5 offset:34816
    s_waitcnt lgkmcnt(10)
    v_mfma_f32_16x16x32_bf16 v[40:43], a[0:3], a[24:27], v[40:43]
    ds_read_b128 a[52:55], v5 offset:36864
    ds_read_b64_tr_b16 a[32:33], v9 offset:40960
    s_waitcnt lgkmcnt(10)
    v_mfma_f32_16x16x32_bf16 v[44:47], a[4:7], a[16:19], v[44:47]
    ds_read_b64_tr_b16 a[34:35], v9 offset:41984
    ds_read_b64_tr_b16 a[36:37], v10 offset:40960
    v_mfma_f32_16x16x32_bf16 v[48:51], a[4:7], a[20:23], v[48:51]
    ds_read_b64_tr_b16 a[38:39], v10 offset:41984
    ds_read_b64_tr_b16 a[40:41], v11 offset:40960
    v_mfma_f32_16x16x32_bf16 v[52:55], a[4:7], a[24:27], v[52:55]
    ds_read_b64_tr_b16 a[42:43], v11 offset:41984
    s_waitcnt lgkmcnt(13)
    v_mfma_f32_16x16x32_bf16 v[56:59], a[8:11], a[16:19], v[56:59]
    v_mfma_f32_16x16x32_bf16 v[60:63], a[8:11], a[20:23], v[60:63]
    v_mfma_f32_16x16x32_bf16 v[64:67], a[8:11], a[24:27], v[64:67]
    s_waitcnt lgkmcnt(11)
    v_mfma_f32_16x16x32_bf16 v[68:71], a[12:15], a[16:19], v[68:71]
    v_mfma_f32_16x16x32_bf16 v[72:75], a[12:15], a[20:23], v[72:75]
    v_mfma_f32_16x16x32_bf16 v[76:79], a[12:15], a[24:27], v[76:79]
    s_waitcnt lgkmcnt(0)
    s_barrier
    v_mfma_f32_16x16x32_bf16 v[32:35], a[28:31], a[44:47], v[32:35]
    ds_read_b64_tr_b16 a[0:1], v12 offset:0
    ds_read_b64_tr_b16 a[2:3], v12 offset:1024
    v_mfma_f32_16x16x32_bf16 v[36:39], a[28:31], a[48:51], v[36:39]
    ds_read_b128 a[16:19], v6 offset:0
    ds_read_b128 a[20:23], v6 offset:2048
    v_mfma_f32_16x16x32_bf16 v[40:43], a[28:31], a[52:55], v[40:43]
    ds_read_b128 a[24:27], v6 offset:4096
    ds_read_b64_tr_b16 a[4:5], v13 offset:0
    v_mfma_f32_16x16x32_bf16 v[44:47], a[32:35], a[44:47], v[44:47]
    ds_read_b64_tr_b16 a[6:7], v13 offset:1024
    ds_read_b64_tr_b16 a[8:9], v14 offset:0
    v_mfma_f32_16x16x32_bf16 v[48:51], a[32:35], a[48:51], v[48:51]
    ds_read_b64_tr_b16 a[10:11], v14 offset:1024
    ds_read_b64_tr_b16 a[12:13], v15 offset:0
    v_mfma_f32_16x16x32_bf16 v[52:55], a[32:35], a[52:55], v[52:55]
    ds_read_b64_tr_b16 a[14:15], v15 offset:1024
    v_mfma_f32_16x16x32_bf16 v[56:59], a[36:39], a[44:47], v[56:59]
    v_mfma_f32_16x16x32_bf16 v[60:63], a[36:39], a[48:51], v[60:63]
    v_mfma_f32_16x16x32_bf16 v[64:67], a[36:39], a[52:55], v[64:67]
    v_mfma_f32_16x16x32_bf16 v[68:71], a[40:43], a[44:47], v[68:71]
    v_mfma_f32_16x16x32_bf16 v[72:75], a[40:43], a[48:51], v[72:75]
    v_mfma_f32_16x16x32_bf16 v[76:79], a[40:43], a[52:55], v[76:79]
    s_waitcnt lgkmcnt(8)
    v_mfma_f32_16x16x32_bf16 v[32:35], a[0:3], a[16:19], v[32:35]
    ds_read_b64_tr_b16 a[28:29], v12 offset:8192
    ds_read_b64_tr_b16 a[30:31], v12 offset:9216
    s_waitcnt lgkmcnt(9)
    v_mfma_f32_16x16x32_bf16 v[36:39], a[0:3], a[20:23], v[36:39]
    ds_read_b128 a[44:47], v7 offset:0
    ds_read_b128 a[48:51], v7 offset:2048
    s_waitcnt lgkmcnt(10)
    v_mfma_f32_16x16x32_bf16 v[40:43], a[0:3], a[24:27], v[40:43]
    ds_read_b128 a[52:55], v7 offset:4096
    ds_read_b64_tr_b16 a[32:33], v13 offset:8192
    s_waitcnt lgkmcnt(10)
    v_mfma_f32_16x16x32_bf16 v[44:47], a[4:7], a[16:19], v[44:47]
    ds_read_b64_tr_b16 a[34:35], v13 offset:9216
    ds_read_b64_tr_b16 a[36:37], v14 offset:8192
    v_mfma_f32_16x16x32_bf16 v[48:51], a[4:7], a[20:23], v[48:51]
    ds_read_b64_tr_b16 a[38:39], v14 offset:9216
    ds_read_b64_tr_b16 a[40:41], v15 offset:8192
    v_mfma_f32_16x16x32_bf16 v[52:55], a[4:7], a[24:27], v[52:55]
    ds_read_b64_tr_b16 a[42:43], v15 offset:9216
    s_waitcnt lgkmcnt(13)
    v_mfma_f32_16x16x32_bf16 v[56:59], a[8:11], a[16:19], v[56:59]
    v_mfma_f32_16x16x32_bf16 v[60:63], a[8:11], a[20:23], v[60:63]
    v_mfma_f32_16x16x32_bf16 v[64:67], a[8:11], a[24:27], v[64:67]
    s_waitcnt lgkmcnt(11)
    v_mfma_f32_16x16x32_bf16 v[68:71], a[12:15], a[16:19], v[68:71]
    v_mfma_f32_16x16x32_bf16 v[72:75], a[12:15], a[20:23], v[72:75]
    v_mfma_f32_16x16x32_bf16 v[76:79], a[12:15], a[24:27], v[76:79]
    s_waitcnt lgkmcnt(0)
    s_barrier
    v_mfma_f32_16x16x32_bf16 v[32:35], a[28:31], a[44:47], v[32:35]
    ds_read_b64_tr_b16 a[0:1], v8 offset:0
    ds_read_b64_tr_b16 a[2:3], v8 offset:1024
    v_mfma_f32_16x16x32_bf16 v[36:39], a[28:31], a[48:51], v[36:39]
    ds_read_b128 a[16:19], v4 offset:0
    ds_read_b128 a[20:23], v4 offset:2048
    v_mfma_f32_16x16x32_bf16 v[40:43], a[28:31], a[52:55], v[40:43]
    ds_read_b128 a[24:27], v4 offset:4096
    ds_read_b64_tr_b16 a[4:5], v9 offset:0
    v_mfma_f32_16x16x32_bf16 v[44:47], a[32:35], a[44:47], v[44:47]
    ds_read_b64_tr_b16 a[6:7], v9 offset:1024
    ds_read_b64_tr_b16 a[8:9], v10 offset:0
    v_mfma_f32_16x16x32_bf16 v[48:51], a[32:35], a[48:51], v[48:51]
    ds_read_b64_tr_b16 a[10:11], v10 offset:1024
    ds_read_b64_tr_b16 a[12:13], v11 offset:0
    v_mfma_f32_16x16x32_bf16 v[52:55], a[32:35], a[52:55], v[52:55]
    ds_read_b64_tr_b16 a[14:15], v11 offset:1024
    v_mfma_f32_16x16x32_bf16 v[56:59], a[36:39], a[44:47], v[56:59]
    v_mfma_f32_16x16x32_bf16 v[60:63], a[36:39], a[48:51], v[60:63]
    v_mfma_f32_16x16x32_bf16 v[64:67], a[36:39], a[52:55], v[64:67]
    v_mfma_f32_16x16x32_bf16 v[68:71], a[40:43], a[44:47], v[68:71]
    v_mfma_f32_16x16x32_bf16 v[72:75], a[40:43], a[48:51], v[72:75]
    v_mfma_f32_16x16x32_bf16 v[76:79], a[40:43], a[52:55], v[76:79]
    s_waitcnt lgkmcnt(8)
    v_mfma_f32_16x16x32_bf16 v[32:35], a[0:3], a[16:19], v[32:35]
    ds_read_b64_tr_b16 a[28:29], v8 offset:8192
    ds_read_b64_tr_b16 a[30:31], v8 offset:9216
    s_waitcnt lgkmcnt(9)
    v_mfma_f32_16x16x32_bf16 v[36:39], a[0:3], a[20:23], v[36:39]
    ds_read_b128 a[44:47], v5 offset:0
    ds_read_b128 a[48:51], v5 offset:2048
    s_waitcnt lgkmcnt(10)
    v_mfma_f32_16x16x32_bf16 v[40:43], a[0:3], a[24:27], v[40:43]
    ds_read_b128 a[52:55], v5 offset:4096
    ds_read_b64_tr_b16 a[32:33], v9 offset:8192
    s_waitcnt lgkmcnt(10)
    v_mfma_f32_16x16x32_bf16 v[44:47], a[4:7], a[16:19], v[44:47]
    ds_read_b64_tr_b16 a[34:35], v9 offset:9216
    ds_read_b64_tr_b16 a[36:37], v10 offset:8192
    v_mfma_f32_16x16x32_bf16 v[48:51], a[4:7], a[20:23], v[48:51]
    ds_read_b64_tr_b16 a[38:39], v10 offset:9216
    ds_read_b64_tr_b16 a[40:41], v11 offset:8192
    v_mfma_f32_16x16x32_bf16 v[52:55], a[4:7], a[24:27], v[52:55]
    ds_read_b64_tr_b16 a[42:43], v11 offset:9216
    s_waitcnt lgkmcnt(13)
    v_mfma_f32_16x16x32_bf16 v[56:59], a[8:11], a[16:19], v[56:59]
    v_mfma_f32_16x16x32_bf16 v[60:63], a[8:11], a[20:23], v[60:63]
    v_mfma_f32_16x16x32_bf16 v[64:67], a[8:11], a[24:27], v[64:67]
    s_waitcnt lgkmcnt(11)
    v_mfma_f32_16x16x32_bf16 v[68:71], a[12:15], a[16:19], v[68:71]
    v_mfma_f32_16x16x32_bf16 v[72:75], a[12:15], a[20:23], v[72:75]
    v_mfma_f32_16x16x32_bf16 v[76:79], a[12:15], a[24:27], v[76:79]
    s_waitcnt lgkmcnt(0)
    s_barrier
    v_mfma_f32_16x16x32_bf16 v[32:35], a[28:31], a[44:47], v[32:35]
    ds_read_b64_tr_b16 a[0:1], v8 offset:32768
    ds_read_b64_tr_b16 a[2:3], v8 offset:33792
    v_mfma_f32_16x16x32_bf16 v[36:39], a[28:31], a[48:51], v[36:39]
    ds_read_b128 a[16:19], v4 offset:32768
    ds_read_b128 a[20:23], v4 offset:34816
    v_mfma_f32_16x16x32_bf16 v[40:43], a[28:31], a[52:55], v[40:43]
    ds_read_b128 a[24:27], v4 offset:36864
    ds_read_b64_tr_b16 a[4:5], v9 offset:32768
    v_mfma_f32_16x16x32_bf16 v[44:47], a[32:35], a[44:47], v[44:47]
    ds_read_b64_tr_b16 a[6:7], v9 offset:33792
    ds_read_b64_tr_b16 a[8:9], v10 offset:32768
    v_mfma_f32_16x16x32_bf16 v[48:51], a[32:35], a[48:51], v[48:51]
    ds_read_b64_tr_b16 a[10:11], v10 offset:33792
    ds_read_b64_tr_b16 a[12:13], v11 offset:32768
    v_mfma_f32_16x16x32_bf16 v[52:55], a[32:35], a[52:55], v[52:55]
    ds_read_b64_tr_b16 a[14:15], v11 offset:33792
    v_mfma_f32_16x16x32_bf16 v[56:59], a[36:39], a[44:47], v[56:59]
    v_mfma_f32_16x16x32_bf16 v[60:63], a[36:39], a[48:51], v[60:63]
    v_mfma_f32_16x16x32_bf16 v[64:67], a[36:39], a[52:55], v[64:67]
    v_mfma_f32_16x16x32_bf16 v[68:71], a[40:43], a[44:47], v[68:71]
    v_mfma_f32_16x16x32_bf16 v[72:75], a[40:43], a[48:51], v[72:75]
    v_mfma_f32_16x16x32_bf16 v[76:79], a[40:43], a[52:55], v[76:79]
    s_waitcnt lgkmcnt(8)
    v_mfma_f32_16x16x32_bf16 v[32:35], a[0:3], a[16:19], v[32:35]
    ds_read_b64_tr_b16 a[28:29], v8 offset:40960
    ds_read_b64_tr_b16 a[30:31], v8 offset:41984
    s_waitcnt lgkmcnt(9)
    v_mfma_f32_16x16x32_bf16 v[36:39], a[0:3], a[20:23], v[36:39]
    ds_read_b128 a[44:47], v5 offset:32768
    ds_read_b128 a[48:51], v5 offset:34816
    s_waitcnt lgkmcnt(10)
    v_mfma_f32_16x16x32_bf16 v[40:43], a[0:3], a[24:27], v[40:43]
    ds_read_b128 a[52:55], v5 offset:36864
    ds_read_b64_tr_b16 a[32:33], v9 offset:40960
    s_waitcnt lgkmcnt(10)
    v_mfma_f32_16x16x32_bf16 v[44:47], a[4:7], a[16:19], v[44:47]
    ds_read_b64_tr_b16 a[34:35], v9 offset:41984
    ds_read_b64_tr_b16 a[36:37], v10 offset:40960
    v_mfma_f32_16x16x32_bf16 v[48:51], a[4:7], a[20:23], v[48:51]
    ds_read_b64_tr_b16 a[38:39], v10 offset:41984
    ds_read_b64_tr_b16 a[40:41], v11 offset:40960
    v_mfma_f32_16x16x32_bf16 v[52:55], a[4:7], a[24:27], v[52:55]
    ds_read_b64_tr_b16 a[42:43], v11 offset:41984
    s_waitcnt lgkmcnt(13)
    v_mfma_f32_16x16x32_bf16 v[56:59], a[8:11], a[16:19], v[56:59]
    v_mfma_f32_16x16x32_bf16 v[60:63], a[8:11], a[20:23], v[60:63]
    v_mfma_f32_16x16x32_bf16 v[64:67], a[8:11], a[24:27], v[64:67]
    s_waitcnt lgkmcnt(11)
    v_mfma_f32_16x16x32_bf16 v[68:71], a[12:15], a[16:19], v[68:71]
    v_mfma_f32_16x16x32_bf16 v[72:75], a[12:15], a[20:23], v[72:75]
    v_mfma_f32_16x16x32_bf16 v[76:79], a[12:15], a[24:27], v[76:79]
    s_waitcnt lgkmcnt(0)
    s_barrier
    v_mfma_f32_16x16x32_bf16 v[32:35], a[28:31], a[44:47], v[32:35]
    ds_read_b64_tr_b16 a[0:1], v12 offset:0
    ds_read_b64_tr_b16 a[2:3], v12 offset:1024
    v_mfma_f32_16x16x32_bf16 v[36:39], a[28:31], a[48:51], v[36:39]
    ds_read_b128 a[16:19], v6 offset:0
    ds_read_b128 a[20:23], v6 offset:2048
    v_mfma_f32_16x16x32_bf16 v[40:43], a[28:31], a[52:55], v[40:43]
    ds_read_b128 a[24:27], v6 offset:4096
    ds_read_b64_tr_b16 a[4:5], v13 offset:0
    v_mfma_f32_16x16x32_bf16 v[44:47], a[32:35], a[44:47], v[44:47]
    ds_read_b64_tr_b16 a[6:7], v13 offset:1024
    ds_read_b64_tr_b16 a[8:9], v14 offset:0
    v_mfma_f32_16x16x32_bf16 v[48:51], a[32:35], a[48:51], v[48:51]
    ds_read_b64_tr_b16 a[10:11], v14 offset:1024
    ds_read_b64_tr_b16 a[12:13], v15 offset:0
    v_mfma_f32_16x16x32_bf16 v[52:55], a[32:35], a[52:55], v[52:55]
    ds_read_b64_tr_b16 a[14:15], v15 offset:1024
    v_xor_b32 v142, 0, v141
    v_mfma_f32_16x16x32_bf16 v[56:59], a[36:39], a[44:47], v[56:59]
    ds_read_b64 v[92:93], v142 offset:0
    ds_read_b64 v[108:109], v142 offset:4096
    v_mfma_f32_16x16x32_bf16 v[60:63], a[36:39], a[48:51], v[60:63]
    ds_read_b64 v[124:125], v142 offset:8192
    v_mfma_f32_16x16x32_bf16 v[64:67], a[36:39], a[52:55], v[64:67]
    v_mfma_f32_16x16x32_bf16 v[68:71], a[40:43], a[44:47], v[68:71]
    v_mfma_f32_16x16x32_bf16 v[72:75], a[40:43], a[48:51], v[72:75]
    v_mfma_f32_16x16x32_bf16 v[76:79], a[40:43], a[52:55], v[76:79]
    s_waitcnt lgkmcnt(11)
    v_mfma_f32_16x16x32_bf16 v[32:35], a[0:3], a[16:19], v[32:35]
    ds_read_b64_tr_b16 a[28:29], v12 offset:8192
    ds_read_b64_tr_b16 a[30:31], v12 offset:9216
    s_waitcnt lgkmcnt(12)
    v_mfma_f32_16x16x32_bf16 v[36:39], a[0:3], a[20:23], v[36:39]
    ds_read_b128 a[44:47], v7 offset:0
    ds_read_b128 a[48:51], v7 offset:2048
    s_waitcnt lgkmcnt(13)
    v_mfma_f32_16x16x32_bf16 v[40:43], a[0:3], a[24:27], v[40:43]
    ds_read_b128 a[52:55], v7 offset:4096
    ds_read_b64_tr_b16 a[32:33], v13 offset:8192
    s_waitcnt lgkmcnt(13)
    v_mfma_f32_16x16x32_bf16 v[44:47], a[4:7], a[16:19], v[44:47]
    ds_read_b64_tr_b16 a[34:35], v13 offset:9216
    ds_read_b64_tr_b16 a[36:37], v14 offset:8192
    v_mfma_f32_16x16x32_bf16 v[48:51], a[4:7], a[20:23], v[48:51]
    ds_read_b64_tr_b16 a[38:39], v14 offset:9216
    ds_read_b64_tr_b16 a[40:41], v15 offset:8192
    v_mfma_f32_16x16x32_bf16 v[52:55], a[4:7], a[24:27], v[52:55]
    ds_read_b64_tr_b16 a[42:43], v15 offset:9216
    v_xor_b32 v142, 128, v141
    s_waitcnt lgkmcnt(14)
    v_mfma_f32_16x16x32_bf16 v[56:59], a[8:11], a[16:19], v[56:59]
    ds_read_b64 v[100:101], v142 offset:0
    ds_read_b64 v[116:117], v142 offset:4096
    v_mfma_f32_16x16x32_bf16 v[60:63], a[8:11], a[20:23], v[60:63]
    ds_read_b64 v[132:133], v142 offset:8192
    v_mfma_f32_16x16x32_bf16 v[64:67], a[8:11], a[24:27], v[64:67]
    v_mfma_f32_16x16x32_bf16 v[68:71], a[12:15], a[16:19], v[68:71]
    v_mfma_f32_16x16x32_bf16 v[72:75], a[12:15], a[20:23], v[72:75]
    v_mfma_f32_16x16x32_bf16 v[76:79], a[12:15], a[24:27], v[76:79]
    s_waitcnt lgkmcnt(0)
    s_barrier
    v_mfma_f32_16x16x32_bf16 v[32:35], a[28:31], a[44:47], v[32:35]
    ds_read_b64_tr_b16 a[0:1], v8 offset:0
    ds_read_b64_tr_b16 a[2:3], v8 offset:1024
    v_mfma_f32_16x16x32_bf16 v[36:39], a[28:31], a[48:51], v[36:39]
    ds_read_b128 a[16:19], v4 offset:0
    ds_read_b128 a[20:23], v4 offset:2048
    v_mfma_f32_16x16x32_bf16 v[40:43], a[28:31], a[52:55], v[40:43]
    ds_read_b128 a[24:27], v4 offset:4096
    ds_read_b64_tr_b16 a[4:5], v9 offset:0
    v_mfma_f32_16x16x32_bf16 v[44:47], a[32:35], a[44:47], v[44:47]
    ds_read_b64_tr_b16 a[6:7], v9 offset:1024
    ds_read_b64_tr_b16 a[8:9], v10 offset:0
    v_mfma_f32_16x16x32_bf16 v[48:51], a[32:35], a[48:51], v[48:51]
    ds_read_b64_tr_b16 a[10:11], v10 offset:1024
    ds_read_b64_tr_b16 a[12:13], v11 offset:0
    v_mfma_f32_16x16x32_bf16 v[52:55], a[32:35], a[52:55], v[52:55]
    ds_read_b64_tr_b16 a[14:15], v11 offset:1024
    v_xor_b32 v143, 32, v141
    v_mfma_f32_16x16x32_bf16 v[56:59], a[36:39], a[44:47], v[56:59]
    ds_read_b64 v[94:95], v143 offset:0
    ds_read_b64 v[110:111], v143 offset:4096
    v_mfma_f32_16x16x32_bf16 v[60:63], a[36:39], a[48:51], v[60:63]
    ds_read_b64 v[126:127], v143 offset:8192
    v_mfma_f32_16x16x32_bf16 v[64:67], a[36:39], a[52:55], v[64:67]
    v_mfma_f32_16x16x32_bf16 v[68:71], a[40:43], a[44:47], v[68:71]
    v_mfma_f32_16x16x32_bf16 v[72:75], a[40:43], a[48:51], v[72:75]
    v_mfma_f32_16x16x32_bf16 v[76:79], a[40:43], a[52:55], v[76:79]
    s_waitcnt lgkmcnt(11)
    v_mfma_f32_16x16x32_bf16 v[32:35], a[0:3], a[16:19], v[32:35]
    ds_read_b64_tr_b16 a[28:29], v8 offset:8192
    ds_read_b64_tr_b16 a[30:31], v8 offset:9216
    s_waitcnt lgkmcnt(12)
    v_mfma_f32_16x16x32_bf16 v[36:39], a[0:3], a[20:23], v[36:39]
    ds_read_b128 a[44:47], v5 offset:0
    ds_read_b128 a[48:51], v5 offset:2048
    s_waitcnt lgkmcnt(13)
    v_mfma_f32_16x16x32_bf16 v[40:43], a[0:3], a[24:27], v[40:43]
    ds_read_b128 a[52:55], v5 offset:4096
    ds_read_b64_tr_b16 a[32:33], v9 offset:8192
    s_waitcnt lgkmcnt(13)
    v_mfma_f32_16x16x32_bf16 v[44:47], a[4:7], a[16:19], v[44:47]
    ds_read_b64_tr_b16 a[34:35], v9 offset:9216
    ds_read_b64_tr_b16 a[36:37], v10 offset:8192
    v_mfma_f32_16x16x32_bf16 v[48:51], a[4:7], a[20:23], v[48:51]
    ds_read_b64_tr_b16 a[38:39], v10 offset:9216
    ds_read_b64_tr_b16 a[40:41], v11 offset:8192
    v_mfma_f32_16x16x32_bf16 v[52:55], a[4:7], a[24:27], v[52:55]
    ds_read_b64_tr_b16 a[42:43], v11 offset:9216
    v_xor_b32 v143, 160, v141
    s_waitcnt lgkmcnt(14)
    v_mfma_f32_16x16x32_bf16 v[56:59], a[8:11], a[16:19], v[56:59]
    ds_read_b64 v[102:103], v143 offset:0
    ds_read_b64 v[118:119], v143 offset:4096
    v_mfma_f32_16x16x32_bf16 v[60:63], a[8:11], a[20:23], v[60:63]
    ds_read_b64 v[134:135], v143 offset:8192
    v_mfma_f32_16x16x32_bf16 v[64:67], a[8:11], a[24:27], v[64:67]
    v_mfma_f32_16x16x32_bf16 v[68:71], a[12:15], a[16:19], v[68:71]
    v_mfma_f32_16x16x32_bf16 v[72:75], a[12:15], a[20:23], v[72:75]
    v_mfma_f32_16x16x32_bf16 v[76:79], a[12:15], a[24:27], v[76:79]
    s_waitcnt lgkmcnt(0)
    s_barrier
    v_mfma_f32_16x16x32_bf16 v[32:35], a[28:31], a[44:47], v[32:35]
    ds_read_b64_tr_b16 a[0:1], v8 offset:32768
    ds_read_b64_tr_b16 a[2:3], v8 offset:33792
    v_mfma_f32_16x16x32_bf16 v[36:39], a[28:31], a[48:51], v[36:39]
    ds_read_b128 a[16:19], v4 offset:32768
    ds_read_b128 a[20:23], v4 offset:34816
    v_mfma_f32_16x16x32_bf16 v[40:43], a[28:31], a[52:55], v[40:43]
    ds_read_b128 a[24:27], v4 offset:36864
    ds_read_b64_tr_b16 a[4:5], v9 offset:32768
    v_mfma_f32_16x16x32_bf16 v[44:47], a[32:35], a[44:47], v[44:47]
    ds_read_b64_tr_b16 a[6:7], v9 offset:33792
    ds_read_b64_tr_b16 a[8:9], v10 offset:32768
    v_mfma_f32_16x16x32_bf16 v[48:51], a[32:35], a[48:51], v[48:51]
    ds_read_b64_tr_b16 a[10:11], v10 offset:33792
    ds_read_b64_tr_b16 a[12:13], v11 offset:32768
    v_mfma_f32_16x16x32_bf16 v[52:55], a[32:35], a[52:55], v[52:55]
    ds_read_b64_tr_b16 a[14:15], v11 offset:33792
    v_xor_b32 v142, 64, v141
    v_mfma_f32_16x16x32_bf16 v[56:59], a[36:39], a[44:47], v[56:59]
    ds_read_b64 v[96:97], v142 offset:0
    ds_read_b64 v[112:113], v142 offset:4096
    v_mfma_f32_16x16x32_bf16 v[60:63], a[36:39], a[48:51], v[60:63]
    ds_read_b64 v[128:129], v142 offset:8192
    v_mfma_f32_16x16x32_bf16 v[64:67], a[36:39], a[52:55], v[64:67]
    v_mfma_f32_16x16x32_bf16 v[68:71], a[40:43], a[44:47], v[68:71]
    v_mfma_f32_16x16x32_bf16 v[72:75], a[40:43], a[48:51], v[72:75]
    v_mfma_f32_16x16x32_bf16 v[76:79], a[40:43], a[52:55], v[76:79]
    s_waitcnt lgkmcnt(11)
    v_mfma_f32_16x16x32_bf16 v[32:35], a[0:3], a[16:19], v[32:35]
    ds_read_b64_tr_b16 a[28:29], v8 offset:40960
    ds_read_b64_tr_b16 a[30:31], v8 offset:41984
    s_waitcnt lgkmcnt(12)
    v_mfma_f32_16x16x32_bf16 v[36:39], a[0:3], a[20:23], v[36:39]
    ds_read_b128 a[44:47], v5 offset:32768
    ds_read_b128 a[48:51], v5 offset:34816
    s_waitcnt lgkmcnt(13)
    v_mfma_f32_16x16x32_bf16 v[40:43], a[0:3], a[24:27], v[40:43]
    ds_read_b128 a[52:55], v5 offset:36864
    ds_read_b64_tr_b16 a[32:33], v9 offset:40960
    s_waitcnt lgkmcnt(13)
    v_mfma_f32_16x16x32_bf16 v[44:47], a[4:7], a[16:19], v[44:47]
    ds_read_b64_tr_b16 a[34:35], v9 offset:41984
    ds_read_b64_tr_b16 a[36:37], v10 offset:40960
    v_mfma_f32_16x16x32_bf16 v[48:51], a[4:7], a[20:23], v[48:51]
    ds_read_b64_tr_b16 a[38:39], v10 offset:41984
    ds_read_b64_tr_b16 a[40:41], v11 offset:40960
    v_mfma_f32_16x16x32_bf16 v[52:55], a[4:7], a[24:27], v[52:55]
    ds_read_b64_tr_b16 a[42:43], v11 offset:41984
    v_xor_b32 v142, 192, v141
    s_waitcnt lgkmcnt(14)
    v_mfma_f32_16x16x32_bf16 v[56:59], a[8:11], a[16:19], v[56:59]
    ds_read_b64 v[104:105], v142 offset:0
    ds_read_b64 v[120:121], v142 offset:4096
    v_mfma_f32_16x16x32_bf16 v[60:63], a[8:11], a[20:23], v[60:63]
    ds_read_b64 v[136:137], v142 offset:8192
    v_mfma_f32_16x16x32_bf16 v[64:67], a[8:11], a[24:27], v[64:67]
    v_mfma_f32_16x16x32_bf16 v[68:71], a[12:15], a[16:19], v[68:71]
    v_mfma_f32_16x16x32_bf16 v[72:75], a[12:15], a[20:23], v[72:75]
    v_mfma_f32_16x16x32_bf16 v[76:79], a[12:15], a[24:27], v[76:79]
    s_waitcnt lgkmcnt(0)
    s_barrier
    v_mfma_f32_16x16x32_bf16 v[32:35], a[28:31], a[44:47], v[32:35]
    ds_read_b64_tr_b16 a[0:1], v12 offset:0
    ds_read_b64_tr_b16 a[2:3], v12 offset:1024
    v_mfma_f32_16x16x32_bf16 v[36:39], a[28:31], a[48:51], v[36:39]
    ds_read_b128 a[16:19], v6 offset:0
    ds_read_b128 a[20:23], v6 offset:2048
    v_mfma_f32_16x16x32_bf16 v[40:43], a[28:31], a[52:55], v[40:43]
    ds_read_b128 a[24:27], v6 offset:4096
    ds_read_b64_tr_b16 a[4:5], v13 offset:0
    v_mfma_f32_16x16x32_bf16 v[44:47], a[32:35], a[44:47], v[44:47]
    ds_read_b64_tr_b16 a[6:7], v13 offset:1024
    ds_read_b64_tr_b16 a[8:9], v14 offset:0
    v_mfma_f32_16x16x32_bf16 v[48:51], a[32:35], a[48:51], v[48:51]
    ds_read_b64_tr_b16 a[10:11], v14 offset:1024
    ds_read_b64_tr_b16 a[12:13], v15 offset:0
    v_mfma_f32_16x16x32_bf16 v[52:55], a[32:35], a[52:55], v[52:55]
    ds_read_b64_tr_b16 a[14:15], v15 offset:1024
    v_and_b32 v20, 3, v1
    v_mfma_f32_16x16x32_bf16 v[56:59], a[36:39], a[44:47], v[56:59]
    v_lshlrev_b32 v20, 2, v20
    buffer_load_dword v140, v20, s[32:35], s68 offen sc1
    v_mfma_f32_16x16x32_bf16 v[60:63], a[36:39], a[48:51], v[60:63]
    v_xor_b32 v143, 96, v141
    ds_read_b64 v[98:99], v143 offset:0
    v_mfma_f32_16x16x32_bf16 v[64:67], a[36:39], a[52:55], v[64:67]
    ds_read_b64 v[114:115], v143 offset:4096
    ds_read_b64 v[130:131], v143 offset:8192
    v_mfma_f32_16x16x32_bf16 v[68:71], a[40:43], a[44:47], v[68:71]
    v_mfma_f32_16x16x32_bf16 v[72:75], a[40:43], a[48:51], v[72:75]
    v_mfma_f32_16x16x32_bf16 v[76:79], a[40:43], a[52:55], v[76:79]
    s_waitcnt lgkmcnt(11)
    v_mfma_f32_16x16x32_bf16 v[32:35], a[0:3], a[16:19], v[32:35]
    ds_read_b64_tr_b16 a[28:29], v12 offset:8192
    ds_read_b64_tr_b16 a[30:31], v12 offset:9216
    s_waitcnt lgkmcnt(12)
    v_mfma_f32_16x16x32_bf16 v[36:39], a[0:3], a[20:23], v[36:39]
    ds_read_b128 a[44:47], v7 offset:0
    ds_read_b128 a[48:51], v7 offset:2048
    s_waitcnt lgkmcnt(13)
    v_mfma_f32_16x16x32_bf16 v[40:43], a[0:3], a[24:27], v[40:43]
    ds_read_b128 a[52:55], v7 offset:4096
    ds_read_b64_tr_b16 a[32:33], v13 offset:8192
    s_waitcnt lgkmcnt(13)
    v_mfma_f32_16x16x32_bf16 v[44:47], a[4:7], a[16:19], v[44:47]
    ds_read_b64_tr_b16 a[34:35], v13 offset:9216
    ds_read_b64_tr_b16 a[36:37], v14 offset:8192
    v_mfma_f32_16x16x32_bf16 v[48:51], a[4:7], a[20:23], v[48:51]
    ds_read_b64_tr_b16 a[38:39], v14 offset:9216
    ds_read_b64_tr_b16 a[40:41], v15 offset:8192
    v_mfma_f32_16x16x32_bf16 v[52:55], a[4:7], a[24:27], v[52:55]
    ds_read_b64_tr_b16 a[42:43], v15 offset:9216
    v_xor_b32 v143, 224, v141
    s_waitcnt lgkmcnt(14)
    v_mfma_f32_16x16x32_bf16 v[56:59], a[8:11], a[16:19], v[56:59]
    ds_read_b64 v[106:107], v143 offset:0
    ds_read_b64 v[122:123], v143 offset:4096
    v_mfma_f32_16x16x32_bf16 v[60:63], a[8:11], a[20:23], v[60:63]
    ds_read_b64 v[138:139], v143 offset:8192
    v_mfma_f32_16x16x32_bf16 v[64:67], a[8:11], a[24:27], v[64:67]
    v_mfma_f32_16x16x32_bf16 v[68:71], a[12:15], a[16:19], v[68:71]
    v_mfma_f32_16x16x32_bf16 v[72:75], a[12:15], a[20:23], v[72:75]
    v_mfma_f32_16x16x32_bf16 v[76:79], a[12:15], a[24:27], v[76:79]
    s_waitcnt lgkmcnt(0)
    s_barrier
    v_mfma_f32_16x16x32_bf16 v[32:35], a[28:31], a[44:47], v[32:35]
    ds_read_b64_tr_b16 a[0:1], v8 offset:0
    ds_read_b64_tr_b16 a[2:3], v8 offset:1024
    v_mfma_f32_16x16x32_bf16 v[36:39], a[28:31], a[48:51], v[36:39]
    ds_read_b128 a[16:19], v4 offset:0
    ds_read_b128 a[20:23], v4 offset:2048
    v_mfma_f32_16x16x32_bf16 v[40:43], a[28:31], a[52:55], v[40:43]
    ds_read_b128 a[24:27], v4 offset:4096
    ds_read_b64_tr_b16 a[4:5], v9 offset:0
    v_mfma_f32_16x16x32_bf16 v[44:47], a[32:35], a[44:47], v[44:47]
    ds_read_b64_tr_b16 a[6:7], v9 offset:1024
    ds_read_b64_tr_b16 a[8:9], v10 offset:0
    v_mfma_f32_16x16x32_bf16 v[48:51], a[32:35], a[48:51], v[48:51]
    ds_read_b64_tr_b16 a[10:11], v10 offset:1024
    ds_read_b64_tr_b16 a[12:13], v11 offset:0
    v_mfma_f32_16x16x32_bf16 v[52:55], a[32:35], a[52:55], v[52:55]
    ds_read_b64_tr_b16 a[14:15], v11 offset:1024
    v_mfma_f32_16x16x32_bf16 v[56:59], a[36:39], a[44:47], v[56:59]
    v_mfma_f32_16x16x32_bf16 v[60:63], a[36:39], a[48:51], v[60:63]
    v_mfma_f32_16x16x32_bf16 v[64:67], a[36:39], a[52:55], v[64:67]
    v_mfma_f32_16x16x32_bf16 v[68:71], a[40:43], a[44:47], v[68:71]
    v_mfma_f32_16x16x32_bf16 v[72:75], a[40:43], a[48:51], v[72:75]
    v_mfma_f32_16x16x32_bf16 v[76:79], a[40:43], a[52:55], v[76:79]
    s_waitcnt lgkmcnt(8)
    v_mfma_f32_16x16x32_bf16 v[32:35], a[0:3], a[16:19], v[32:35]
    ds_read_b64_tr_b16 a[28:29], v8 offset:8192
    ds_read_b64_tr_b16 a[30:31], v8 offset:9216
    s_waitcnt lgkmcnt(6)
    v_mfma_f32_16x16x32_bf16 v[44:47], a[4:7], a[16:19], v[44:47]
    ds_read_b128 a[44:47], v5 offset:0
    ds_read_b128 a[48:51], v5 offset:2048
    v_mfma_f32_16x16x32_bf16 v[36:39], a[0:3], a[20:23], v[36:39]
    ds_read_b128 a[52:55], v5 offset:4096
    ds_read_b64_tr_b16 a[32:33], v9 offset:8192
    v_mfma_f32_16x16x32_bf16 v[48:51], a[4:7], a[20:23], v[48:51]
    ds_read_b64_tr_b16 a[34:35], v9 offset:9216
    ds_read_b64_tr_b16 a[36:37], v10 offset:8192
    v_mfma_f32_16x16x32_bf16 v[40:43], a[0:3], a[24:27], v[40:43]
    ds_read_b64_tr_b16 a[38:39], v10 offset:9216
    ds_read_b64_tr_b16 a[40:41], v11 offset:8192
    v_mfma_f32_16x16x32_bf16 v[52:55], a[4:7], a[24:27], v[52:55]
    ds_read_b64_tr_b16 a[42:43], v11 offset:9216
    s_waitcnt lgkmcnt(8)
    v_mfma_f32_16x16x32_bf16 v[32:35], a[28:31], a[44:47], v[32:35]
    s_waitcnt lgkmcnt(4)
    v_mfma_f32_16x16x32_bf16 v[44:47], a[32:35], a[44:47], v[44:47]
    v_mfma_f32_16x16x32_bf16 v[36:39], a[28:31], a[48:51], v[36:39]
    v_mfma_f32_16x16x32_bf16 v[48:51], a[32:35], a[48:51], v[48:51]
    v_mfma_f32_16x16x32_bf16 v[40:43], a[28:31], a[52:55], v[40:43]
    v_mfma_f32_16x16x32_bf16 v[52:55], a[32:35], a[52:55], v[52:55]
    v_mfma_f32_16x16x32_bf16 v[56:59], a[8:11], a[16:19], v[56:59]
    v_mfma_f32_16x16x32_bf16 v[68:71], a[12:15], a[16:19], v[68:71]
    s_waitcnt lgkmcnt(2)
    v_mfma_f32_16x16x32_bf16 v[56:59], a[36:39], a[44:47], v[56:59]
    s_waitcnt lgkmcnt(0)
    v_mfma_f32_16x16x32_bf16 v[68:71], a[40:43], a[44:47], v[68:71]
    v_cvt_pk_bf16_f32 v32, v32, v33
    v_cvt_pk_bf16_f32 v33, v34, v35
    v_mfma_f32_16x16x32_bf16 v[60:63], a[8:11], a[20:23], v[60:63]
    v_cvt_pk_bf16_f32 v34, v44, v45
    v_cvt_pk_bf16_f32 v35, v46, v47
    v_mfma_f32_16x16x32_bf16 v[72:75], a[12:15], a[20:23], v[72:75]
    ds_write_b128 v86, v[32:35] offset:0
    v_cvt_pk_bf16_f32 v36, v36, v37
    v_mfma_f32_16x16x32_bf16 v[60:63], a[36:39], a[48:51], v[60:63]
    v_cvt_pk_bf16_f32 v37, v38, v39
    v_cvt_pk_bf16_f32 v38, v48, v49
    v_mfma_f32_16x16x32_bf16 v[72:75], a[40:43], a[48:51], v[72:75]
    v_cvt_pk_bf16_f32 v39, v50, v51
    ds_write_b128 v86, v[36:39] offset:4096
    v_mfma_f32_16x16x32_bf16 v[64:67], a[8:11], a[24:27], v[64:67]
    v_cvt_pk_bf16_f32 v40, v40, v41
    v_cvt_pk_bf16_f32 v41, v42, v43
    v_mfma_f32_16x16x32_bf16 v[76:79], a[12:15], a[24:27], v[76:79]
    v_cvt_pk_bf16_f32 v42, v52, v53
    v_cvt_pk_bf16_f32 v43, v54, v55
    v_mfma_f32_16x16x32_bf16 v[64:67], a[36:39], a[52:55], v[64:67]
    ds_write_b128 v86, v[40:43] offset:8192
    v_cvt_pk_bf16_f32 v56, v56, v57
    v_mfma_f32_16x16x32_bf16 v[76:79], a[40:43], a[52:55], v[76:79]
    v_cvt_pk_bf16_f32 v57, v58, v59
    v_cvt_pk_bf16_f32 v58, v68, v69
    v_cvt_pk_bf16_f32 v59, v70, v71
    ds_write_b128 v86, v[56:59] offset:1024
    v_cvt_pk_bf16_f32 v60, v60, v61
    v_cvt_pk_bf16_f32 v61, v62, v63
    v_cvt_pk_bf16_f32 v62, v72, v73
    v_cvt_pk_bf16_f32 v63, v74, v75
    ds_write_b128 v86, v[60:63] offset:5120
    v_cvt_pk_bf16_f32 v64, v64, v65
    v_cvt_pk_bf16_f32 v65, v66, v67
    v_cvt_pk_bf16_f32 v66, v76, v77
    v_cvt_pk_bf16_f32 v67, v78, v79
    ds_write_b128 v86, v[64:67] offset:9216
    s_waitcnt lgkmcnt(0)
    s_branch L_p2
L_attn:
    s_setprio 3
    s_barrier
    ds_read_b128 v[64:67], v85 offset:0
    ds_read_b128 v[68:71], v85 offset:1024
    ds_read_b128 v[72:75], v85 offset:2048
    ds_read_b128 v[76:79], v85 offset:3072
    s_mov_b32 s14, 0x3e0293ee
    s_waitcnt lgkmcnt(3)
    v_mfma_f32_16x16x32_bf16 v[32:35], v[92:95], v[64:67], 0
    v_mfma_f32_16x16x32_bf16 v[36:39], v[108:111], v[64:67], 0
    v_mfma_f32_16x16x32_bf16 v[40:43], v[124:127], v[64:67], 0
    s_waitcnt lgkmcnt(2)
    v_mfma_f32_16x16x32_bf16 v[32:35], v[96:99], v[68:71], v[32:35]
    v_mfma_f32_16x16x32_bf16 v[36:39], v[112:115], v[68:71], v[36:39]
    v_mfma_f32_16x16x32_bf16 v[40:43], v[128:131], v[68:71], v[40:43]
    s_waitcnt lgkmcnt(1)
    v_mfma_f32_16x16x32_bf16 v[32:35], v[100:103], v[72:75], v[32:35]
    v_mfma_f32_16x16x32_bf16 v[36:39], v[116:119], v[72:75], v[36:39]
    v_mfma_f32_16x16x32_bf16 v[40:43], v[132:135], v[72:75], v[40:43]
    s_waitcnt lgkmcnt(0)
    v_mfma_f32_16x16x32_bf16 v[32:35], v[104:107], v[76:79], v[32:35]
    v_mfma_f32_16x16x32_bf16 v[36:39], v[120:123], v[76:79], v[36:39]
    v_mfma_f32_16x16x32_bf16 v[40:43], v[136:139], v[76:79], v[40:43]
    s_waitcnt vmcnt(0)
    v_cmp_ne_u32 vcc, s67, v140
    s_mov_b64 s[56:57], vcc
    s_barrier
    s_nop 4
    v_max3_f32 v50, v32, v33, v34
    v_max3_f32 v51, v35, v36, v37
    v_max3_f32 v50, v50, v38, v39
    v_max3_f32 v51, v51, v40, v41
    v_max3_f32 v50, v50, v42, v43
    v_max_f32 v50, v50, v51
    v_mov_b32 v51, v50
    s_nop 1
    v_permlane32_swap_b32 v50, v51
    s_nop 1
    v_max_f32 v50, v50, v51
    v_mov_b32 v51, v50
    s_nop 1
    v_permlane16_swap_b32 v50, v51
    s_nop 1
    v_max_f32 v50, v50, v51
    v_mul_f32 v50, s14, v50
    v_fma_f32 v32, v32, s14, -v50
    v_fma_f32 v33, v33, s14, -v50
    v_fma_f32 v34, v34, s14, -v50
    v_fma_f32 v35, v35, s14, -v50
    v_fma_f32 v36, v36, s14, -v50
    v_fma_f32 v37, v37, s14, -v50
    v_fma_f32 v38, v38, s14, -v50
    v_fma_f32 v39, v39, s14, -v50
    v_fma_f32 v40, v40, s14, -v50
    v_fma_f32 v41, v41, s14, -v50
    v_fma_f32 v42, v42, s14, -v50
    v_fma_f32 v43, v43, s14, -v50
    v_exp_f32 v32, v32
    s_barrier
    v_exp_f32 v33, v33
    v_exp_f32 v34, v34
    v_exp_f32 v35, v35
    v_exp_f32 v36, v36
    v_pk_add_f32 v[52:53], v[32:33], v[34:35]
    v_exp_f32 v37, v37
    v_exp_f32 v38, v38
    v_pk_add_f32 v[52:53], v[52:53], v[36:37]
    v_exp_f32 v39, v39
    v_exp_f32 v40, v40
    v_pk_add_f32 v[52:53], v[52:53], v[38:39]
    v_exp_f32 v41, v41
    v_exp_f32 v42, v42
    v_pk_add_f32 v[52:53], v[52:53], v[40:41]
    v_exp_f32 v43, v43
    s_nop 0
    v_pk_add_f32 v[52:53], v[52:53], v[42:43]
    v_add_f32 v50, v52, v53
    v_mov_b32 v51, v50
    s_nop 1
    v_permlane32_swap_b32 v50, v51
    s_nop 1
    v_add_f32 v50, v50, v51
    v_mov_b32 v51, v50
    s_nop 1
    v_permlane16_swap_b32 v50, v51
    s_nop 1
    v_add_f32 v50, v50, v51
    v_rcp_f32 v50, v50
    s_nop 0
    v_mov_b32 v51, v50
    v_pk_mul_f32 v[32:33], v[32:33], v[50:51]
    v_pk_mul_f32 v[34:35], v[34:35], v[50:51]
    v_pk_mul_f32 v[36:37], v[36:37], v[50:51]
    v_pk_mul_f32 v[38:39], v[38:39], v[50:51]
    v_pk_mul_f32 v[40:41], v[40:41], v[50:51]
    v_pk_mul_f32 v[42:43], v[42:43], v[50:51]
    v_cvt_pk_bf16_f32 v44, v32, v33
    v_cvt_pk_bf16_f32 v45, v34, v35
    v_cvt_pk_bf16_f32 v46, v36, v37
    v_cvt_pk_bf16_f32 v47, v38, v39
    v_cvt_pk_bf16_f32 v48, v40, v41
    v_cvt_pk_bf16_f32 v49, v42, v43
    buffer_store_dwordx4 v[44:47], v3, s[32:35], s63 offen sc1
    buffer_store_dwordx2 v[48:49], v82, s[32:35], s63 offen offset:1024 sc1
    ds_write_b128 v80, v[44:47]
    ds_write_b64 v81, v[48:49] offset:1024
    v_min_u32 v21, 11, v1
    v_lshlrev_b32 v21, 2, v21
    s_mul_i32 s54, s58, 4608
    s_add_u32 s45, s45, s54
    s_add_u32 s44, s54, 65536
    s_mov_b32 s53, 0
    s_waitcnt lgkmcnt(0)
    s_barrier
    s_waitcnt vmcnt(0)
    s_mov_b64 exec, 1
    s_cmp_lg_u64 s[56:57], 0
    s_cbranch_scc1 L_fg_20
    buffer_store_dword v84, v83, s[32:35], s64 offen
    s_branch L_fd_21
L_fg_20:
    buffer_store_dword v84, v83, s[32:35], s64 offen sc1
L_fd_21:
    s_mov_b64 exec, -1
    s_barrier
    s_mov_b32 s15, 0
    s_add_u32 s54, s7, 1
    s_and_b32 s54, s54, 3
    s_mul_i32 s54, s54, 3
    s_lshl_b32 s54, 7, s54
    s_or_b32 s15, s15, s54
L_pf_22:
    buffer_load_dword v23, v21, s[32:35], s62 offen sc1
    s_add_u32 s53, s53, 1
    s_cmp_ge_u32 s53, 0x100000
    s_cbranch_scc1 L_gf_23
    s_waitcnt vmcnt(0)
    v_cmp_eq_u32 vcc, s52, v23
    s_andn2_b32 s54, s15, vcc_lo
    s_cbranch_scc1 L_pf_22
L_gf_23:
    s_add_u32 s54, s7, 1
    s_and_b32 s54, s54, 3
    s_mul_i32 s54, s54, 9216
    s_add_u32 m0, s44, 9216
    s_add_u32 s54, s54, s45
    buffer_load_dwordx4 v3, s[32:35], s54 offen offset:0 sc1 lds
    buffer_load_dwordx4 v3, s[32:35], s54 offen offset:1024 sc1 lds
    buffer_load_dwordx4 v3, s[32:35], s54 offen offset:2048 sc1 lds
    buffer_load_dwordx4 v3, s[32:35], s54 offen offset:3072 sc1 lds
    s_add_u32 m0, s44, 13312
    s_add_u32 s54, s54, 4096
    s_mov_b32 exec_hi, 0
    buffer_load_dwordx4 v3, s[32:35], s54 offen sc1 lds
    s_mov_b32 exec_hi, -1
    s_barrier
    s_waitcnt vmcnt(0)
    s_barrier
    s_mov_b32 s15, 0
    s_add_u32 s54, s7, 2
    s_and_b32 s54, s54, 3
    s_mul_i32 s54, s54, 3
    s_lshl_b32 s54, 7, s54
    s_or_b32 s15, s15, s54
    s_add_u32 s54, s7, 3
    s_and_b32 s54, s54, 3
    s_mul_i32 s54, s54, 3
    s_lshl_b32 s54, 7, s54
    s_or_b32 s15, s15, s54
L_pf_24:
    buffer_load_dword v23, v21, s[32:35], s62 offen sc1
    s_add_u32 s53, s53, 1
    s_cmp_ge_u32 s53, 0x100000
    s_cbranch_scc1 L_gf_25
    s_waitcnt vmcnt(0)
    v_cmp_eq_u32 vcc, s52, v23
    s_andn2_b32 s54, s15, vcc_lo
    s_cbranch_scc1 L_pf_24
L_gf_25:
    s_add_u32 s54, s7, 2
    s_and_b32 s54, s54, 3
    s_mul_i32 s54, s54, 9216
    s_add_u32 m0, s44, 18432
    s_add_u32 s54, s54, s45
    buffer_load_dwordx4 v3, s[32:35], s54 offen offset:0 sc1 lds
    buffer_load_dwordx4 v3, s[32:35], s54 offen offset:1024 sc1 lds
    buffer_load_dwordx4 v3, s[32:35], s54 offen offset:2048 sc1 lds
    buffer_load_dwordx4 v3, s[32:35], s54 offen offset:3072 sc1 lds
    s_add_u32 m0, s44, 22528
    s_add_u32 s54, s54, 4096
    s_mov_b32 exec_hi, 0
    buffer_load_dwordx4 v3, s[32:35], s54 offen sc1 lds
    s_mov_b32 exec_hi, -1
    s_add_u32 s54, s7, 3
    s_and_b32 s54, s54, 3
    s_mul_i32 s54, s54, 9216
    s_add_u32 m0, s44, 0
    s_add_u32 s54, s54, s45
    buffer_load_dwordx4 v3, s[32:35], s54 offen offset:0 sc1 lds
    buffer_load_dwordx4 v3, s[32:35], s54 offen offset:1024 sc1 lds
    buffer_load_dwordx4 v3, s[32:35], s54 offen offset:2048 sc1 lds
    buffer_load_dwordx4 v3, s[32:35], s54 offen offset:3072 sc1 lds
    s_add_u32 m0, s44, 4096
    s_add_u32 s54, s54, 4096
    s_mov_b32 exec_hi, 0
    buffer_load_dwordx4 v3, s[32:35], s54 offen sc1 lds
    s_mov_b32 exec_hi, -1
    s_barrier
    s_waitcnt vmcnt(0)
    s_barrier
    s_branch L_reducer
L_p2:
    s_setprio 1
    v_add_u32 v4, 131072, v4
    v_add_u32 v5, 131072, v5
    v_add_u32 v6, 131072, v87
    v_add_u32 v7, 131072, v88
    v_add_u32 v0, s44, v3
    v_add_u32 v1, s44, v82
    s_barrier
    ds_read_b128 v[64:67], v85 offset:0
    ds_read_b128 v[68:71], v85 offset:1024
    ds_read_b128 v[72:75], v85 offset:2048
    ds_read_b128 v[76:79], v85 offset:3072
    s_mov_b32 s14, 0x3e0293ee
    s_waitcnt lgkmcnt(3)
    v_mfma_f32_16x16x32_bf16 v[32:35], v[92:95], v[64:67], 0
    v_mfma_f32_16x16x32_bf16 v[36:39], v[108:111], v[64:67], 0
    v_mfma_f32_16x16x32_bf16 v[40:43], v[124:127], v[64:67], 0
    s_waitcnt lgkmcnt(2)
    v_mfma_f32_16x16x32_bf16 v[32:35], v[96:99], v[68:71], v[32:35]
    v_mfma_f32_16x16x32_bf16 v[36:39], v[112:115], v[68:71], v[36:39]
    v_mfma_f32_16x16x32_bf16 v[40:43], v[128:131], v[68:71], v[40:43]
    s_waitcnt lgkmcnt(1)
    v_mfma_f32_16x16x32_bf16 v[32:35], v[100:103], v[72:75], v[32:35]
    v_mfma_f32_16x16x32_bf16 v[36:39], v[116:119], v[72:75], v[36:39]
    v_mfma_f32_16x16x32_bf16 v[40:43], v[132:135], v[72:75], v[40:43]
    s_waitcnt lgkmcnt(0)
    v_mfma_f32_16x16x32_bf16 v[32:35], v[104:107], v[76:79], v[32:35]
    v_mfma_f32_16x16x32_bf16 v[36:39], v[120:123], v[76:79], v[36:39]
    v_mfma_f32_16x16x32_bf16 v[40:43], v[136:139], v[76:79], v[40:43]
    s_waitcnt vmcnt(0)
    v_cmp_ne_u32 vcc, s67, v140
    s_mov_b64 s[56:57], vcc
    s_barrier
    ds_read_b64_tr_b16 a[12:13], v6 offset:0
    ds_read_b64_tr_b16 a[14:15], v6 offset:1280
    ds_read_b128 a[0:3], v4 offset:0
    ds_read_b128 a[4:7], v4 offset:2048
    ds_read_b128 a[8:11], v4 offset:4096
    ds_read_b64_tr_b16 a[16:17], v7 offset:32
    ds_read_b64_tr_b16 a[18:19], v7 offset:1312
    ds_read_b64_tr_b16 a[20:21], v6 offset:64
    ds_read_b64_tr_b16 a[22:23], v6 offset:1344
    ds_read_b64_tr_b16 a[24:25], v7 offset:96
    ds_read_b64_tr_b16 a[26:27], v7 offset:1376
    ds_read_b64_tr_b16 a[28:29], v6 offset:128
    ds_read_b64_tr_b16 a[30:31], v6 offset:1408
    v_max3_f32 v50, v32, v33, v34
    v_max3_f32 v51, v35, v36, v37
    v_max3_f32 v50, v50, v38, v39
    v_max3_f32 v51, v51, v40, v41
    v_max3_f32 v50, v50, v42, v43
    v_max_f32 v50, v50, v51
    v_mov_b32 v51, v50
    s_nop 1
    v_permlane32_swap_b32 v50, v51
    s_nop 1
    v_max_f32 v50, v50, v51
    v_mov_b32 v51, v50
    s_nop 1
    v_permlane16_swap_b32 v50, v51
    s_nop 1
    v_max_f32 v50, v50, v51
    v_mul_f32 v50, s14, v50
    s_waitcnt lgkmcnt(10)
    v_mfma_f32_16x16x32_bf16 v[92:95], a[0:3], a[12:15], 0
    ds_read_b64_tr_b16 a[44:45], v6 offset:10240
    ds_read_b64_tr_b16 a[46:47], v6 offset:11520
    s_waitcnt lgkmcnt(11)
    v_mfma_f32_16x16x32_bf16 v[96:99], a[4:7], a[12:15], 0
    ds_read_b128 a[32:35], v5 offset:0
    ds_read_b128 a[36:39], v5 offset:2048
    s_waitcnt lgkmcnt(12)
    v_mfma_f32_16x16x32_bf16 v[100:103], a[8:11], a[12:15], 0
    ds_read_b128 a[40:43], v5 offset:4096
    ds_read_b64_tr_b16 a[48:49], v7 offset:10272
    s_waitcnt lgkmcnt(12)
    v_mfma_f32_16x16x32_bf16 v[104:107], a[0:3], a[16:19], 0
    ds_read_b64_tr_b16 a[50:51], v7 offset:11552
    ds_read_b64_tr_b16 a[52:53], v6 offset:10304
    v_mfma_f32_16x16x32_bf16 v[108:111], a[4:7], a[16:19], 0
    ds_read_b64_tr_b16 a[54:55], v6 offset:11584
    ds_read_b64_tr_b16 a[56:57], v7 offset:10336
    v_mfma_f32_16x16x32_bf16 v[112:115], a[8:11], a[16:19], 0
    ds_read_b64_tr_b16 a[58:59], v7 offset:11616
    ds_read_b64_tr_b16 a[60:61], v6 offset:10368
    s_waitcnt lgkmcnt(14)
    v_mfma_f32_16x16x32_bf16 v[116:119], a[0:3], a[20:23], 0
    ds_read_b64_tr_b16 a[62:63], v6 offset:11648
    v_fma_f32 v32, v32, s14, -v50
    v_mfma_f32_16x16x32_bf16 v[120:123], a[4:7], a[20:23], 0
    v_fma_f32 v33, v33, s14, -v50
    v_fma_f32 v34, v34, s14, -v50
    v_mfma_f32_16x16x32_bf16 v[124:127], a[8:11], a[20:23], 0
    v_fma_f32 v35, v35, s14, -v50
    v_fma_f32 v36, v36, s14, -v50
    v_mfma_f32_16x16x32_bf16 v[128:131], a[0:3], a[24:27], 0
    v_fma_f32 v37, v37, s14, -v50
    v_fma_f32 v38, v38, s14, -v50
    v_mfma_f32_16x16x32_bf16 v[132:135], a[4:7], a[24:27], 0
    v_fma_f32 v39, v39, s14, -v50
    v_fma_f32 v40, v40, s14, -v50
    v_mfma_f32_16x16x32_bf16 v[136:139], a[8:11], a[24:27], 0
    v_fma_f32 v41, v41, s14, -v50
    v_fma_f32 v42, v42, s14, -v50
    s_waitcnt lgkmcnt(13)
    v_mfma_f32_16x16x32_bf16 v[140:143], a[0:3], a[28:31], 0
    v_fma_f32 v43, v43, s14, -v50
    v_exp_f32 v32, v32
    v_mfma_f32_16x16x32_bf16 v[144:147], a[4:7], a[28:31], 0
    v_exp_f32 v33, v33
    v_exp_f32 v34, v34
    v_mfma_f32_16x16x32_bf16 v[148:151], a[8:11], a[28:31], 0
    v_add_f32 v52, v32, v33
    v_exp_f32 v35, v35
    s_waitcnt lgkmcnt(0)
    s_barrier
    v_mfma_f32_16x16x32_bf16 v[92:95], a[32:35], a[44:47], v[92:95]
    v_add_u32 v4, 0xfffe8000, v4
    v_add_u32 v5, 0xfffe8000, v5
    v_mfma_f32_16x16x32_bf16 v[96:99], a[36:39], a[44:47], v[96:99]
    v_add_u32 v6, 0xfffe8000, v6
    v_add_u32 v7, 0xfffe8000, v7
    v_mfma_f32_16x16x32_bf16 v[100:103], a[40:43], a[44:47], v[100:103]
    ds_read_b64_tr_b16 a[12:13], v6 offset:0
    ds_read_b64_tr_b16 a[14:15], v6 offset:1280
    v_mfma_f32_16x16x32_bf16 v[104:107], a[32:35], a[48:51], v[104:107]
    ds_read_b128 a[0:3], v4 offset:0
    ds_read_b128 a[4:7], v4 offset:2048
    v_mfma_f32_16x16x32_bf16 v[108:111], a[36:39], a[48:51], v[108:111]
    ds_read_b128 a[8:11], v4 offset:4096
    ds_read_b64_tr_b16 a[16:17], v7 offset:32
    v_mfma_f32_16x16x32_bf16 v[112:115], a[40:43], a[48:51], v[112:115]
    ds_read_b64_tr_b16 a[18:19], v7 offset:1312
    ds_read_b64_tr_b16 a[20:21], v6 offset:64
    v_mfma_f32_16x16x32_bf16 v[116:119], a[32:35], a[52:55], v[116:119]
    ds_read_b64_tr_b16 a[22:23], v6 offset:1344
    ds_read_b64_tr_b16 a[24:25], v7 offset:96
    v_mfma_f32_16x16x32_bf16 v[120:123], a[36:39], a[52:55], v[120:123]
    ds_read_b64_tr_b16 a[26:27], v7 offset:1376
    ds_read_b64_tr_b16 a[28:29], v6 offset:128
    v_mfma_f32_16x16x32_bf16 v[124:127], a[40:43], a[52:55], v[124:127]
    ds_read_b64_tr_b16 a[30:31], v6 offset:1408
    v_add_f32 v52, v52, v34
    v_mfma_f32_16x16x32_bf16 v[128:131], a[32:35], a[56:59], v[128:131]
    v_exp_f32 v36, v36
    v_add_f32 v52, v52, v35
    v_mfma_f32_16x16x32_bf16 v[132:135], a[36:39], a[56:59], v[132:135]
    v_exp_f32 v37, v37
    v_add_f32 v52, v52, v36
    v_mfma_f32_16x16x32_bf16 v[136:139], a[40:43], a[56:59], v[136:139]
    v_exp_f32 v38, v38
    v_add_f32 v52, v52, v37
    v_mfma_f32_16x16x32_bf16 v[140:143], a[32:35], a[60:63], v[140:143]
    v_exp_f32 v39, v39
    v_add_f32 v52, v52, v38
    v_mfma_f32_16x16x32_bf16 v[144:147], a[36:39], a[60:63], v[144:147]
    v_exp_f32 v40, v40
    v_add_f32 v52, v52, v39
    v_mfma_f32_16x16x32_bf16 v[148:151], a[40:43], a[60:63], v[148:151]
    v_exp_f32 v41, v41
    v_add_f32 v52, v52, v40
    s_waitcnt lgkmcnt(10)
    v_mfma_f32_16x16x32_bf16 v[92:95], a[0:3], a[12:15], v[92:95]
    ds_read_b64_tr_b16 a[44:45], v6 offset:10240
    ds_read_b64_tr_b16 a[46:47], v6 offset:11520
    s_waitcnt lgkmcnt(11)
    v_mfma_f32_16x16x32_bf16 v[96:99], a[4:7], a[12:15], v[96:99]
    ds_read_b128 a[32:35], v5 offset:0
    ds_read_b128 a[36:39], v5 offset:2048
    s_waitcnt lgkmcnt(12)
    v_mfma_f32_16x16x32_bf16 v[100:103], a[8:11], a[12:15], v[100:103]
    ds_read_b128 a[40:43], v5 offset:4096
    ds_read_b64_tr_b16 a[48:49], v7 offset:10272
    s_waitcnt lgkmcnt(12)
    v_mfma_f32_16x16x32_bf16 v[104:107], a[0:3], a[16:19], v[104:107]
    ds_read_b64_tr_b16 a[50:51], v7 offset:11552
    ds_read_b64_tr_b16 a[52:53], v6 offset:10304
    v_mfma_f32_16x16x32_bf16 v[108:111], a[4:7], a[16:19], v[108:111]
    ds_read_b64_tr_b16 a[54:55], v6 offset:11584
    ds_read_b64_tr_b16 a[56:57], v7 offset:10336
    v_mfma_f32_16x16x32_bf16 v[112:115], a[8:11], a[16:19], v[112:115]
    ds_read_b64_tr_b16 a[58:59], v7 offset:11616
    ds_read_b64_tr_b16 a[60:61], v6 offset:10368
    s_waitcnt lgkmcnt(14)
    v_mfma_f32_16x16x32_bf16 v[116:119], a[0:3], a[20:23], v[116:119]
    ds_read_b64_tr_b16 a[62:63], v6 offset:11648
    v_exp_f32 v42, v42
    v_mfma_f32_16x16x32_bf16 v[120:123], a[4:7], a[20:23], v[120:123]
    v_add_f32 v52, v52, v41
    v_exp_f32 v43, v43
    v_mfma_f32_16x16x32_bf16 v[124:127], a[8:11], a[20:23], v[124:127]
    v_add_f32 v52, v52, v42
    v_add_f32 v50, v52, v43
    v_mfma_f32_16x16x32_bf16 v[128:131], a[0:3], a[24:27], v[128:131]
    v_mov_b32 v51, v50
    s_nop 1
    v_permlane32_swap_b32 v50, v51
    v_mfma_f32_16x16x32_bf16 v[132:135], a[4:7], a[24:27], v[132:135]
    s_nop 1
    v_add_f32 v50, v50, v51
    v_mov_b32 v51, v50
    v_mfma_f32_16x16x32_bf16 v[136:139], a[8:11], a[24:27], v[136:139]
    s_nop 1
    v_permlane16_swap_b32 v50, v51
    s_nop 1
    v_add_f32 v50, v50, v51
    s_waitcnt lgkmcnt(13)
    v_mfma_f32_16x16x32_bf16 v[140:143], a[0:3], a[28:31], v[140:143]
    v_rcp_f32 v50, v50
    s_nop 0
    v_mul_f32 v32, v32, v50
    v_mfma_f32_16x16x32_bf16 v[144:147], a[4:7], a[28:31], v[144:147]
    v_mul_f32 v33, v33, v50
    v_mul_f32 v34, v34, v50
    v_mfma_f32_16x16x32_bf16 v[148:151], a[8:11], a[28:31], v[148:151]
    v_mul_f32 v35, v35, v50
    v_mul_f32 v36, v36, v50
    v_mul_f32 v37, v37, v50
    v_mul_f32 v38, v38, v50
    v_mul_f32 v39, v39, v50
    v_mul_f32 v40, v40, v50
    v_mul_f32 v41, v41, v50
    v_mul_f32 v42, v42, v50
    v_mul_f32 v43, v43, v50
    v_cvt_pk_bf16_f32 v44, v32, v33
    v_cvt_pk_bf16_f32 v45, v34, v35
    v_cvt_pk_bf16_f32 v46, v36, v37
    v_cvt_pk_bf16_f32 v47, v38, v39
    v_cvt_pk_bf16_f32 v48, v40, v41
    v_cvt_pk_bf16_f32 v49, v42, v43
    buffer_store_dwordx4 v[44:47], v3, s[32:35], s63 offen sc1
    buffer_store_dwordx2 v[48:49], v82, s[32:35], s63 offen offset:1024 sc1
    ds_write_b128 v80, v[44:47]
    ds_write_b64 v81, v[48:49] offset:1024
    s_waitcnt lgkmcnt(0)
    s_barrier
    v_mfma_f32_16x16x32_bf16 v[92:95], a[32:35], a[44:47], v[92:95]
    v_add_u32 v4, 0x10000, v4
    v_add_u32 v5, 0x10000, v5
    v_add_u32 v6, 0x10000, v6
    v_mfma_f32_16x16x32_bf16 v[96:99], a[36:39], a[44:47], v[96:99]
    v_add_u32 v7, 0x10000, v7
    ds_read_b64_tr_b16 a[12:13], v6 offset:0
    ds_read_b64_tr_b16 a[14:15], v6 offset:1280
    v_mfma_f32_16x16x32_bf16 v[100:103], a[40:43], a[44:47], v[100:103]
    ds_read_b128 a[0:3], v4 offset:0
    ds_read_b128 a[4:7], v4 offset:2048
    ds_read_b128 a[8:11], v4 offset:4096
    v_mfma_f32_16x16x32_bf16 v[104:107], a[32:35], a[48:51], v[104:107]
    ds_read_b64_tr_b16 a[16:17], v7 offset:32
    ds_read_b64_tr_b16 a[18:19], v7 offset:1312
    ds_read_b64_tr_b16 a[20:21], v6 offset:64
    v_mfma_f32_16x16x32_bf16 v[108:111], a[36:39], a[48:51], v[108:111]
    ds_read_b64_tr_b16 a[22:23], v6 offset:1344
    ds_read_b64_tr_b16 a[24:25], v7 offset:96
    ds_read_b64_tr_b16 a[26:27], v7 offset:1376
    v_mfma_f32_16x16x32_bf16 v[112:115], a[40:43], a[48:51], v[112:115]
    ds_read_b64_tr_b16 a[28:29], v6 offset:128
    ds_read_b64_tr_b16 a[30:31], v6 offset:1408
    v_cvt_pk_bf16_f32 v152, v92, v93
    v_mfma_f32_16x16x32_bf16 v[116:119], a[32:35], a[52:55], v[116:119]
    v_cvt_pk_bf16_f32 v153, v94, v95
    v_cvt_pk_bf16_f32 v154, v96, v97
    v_cvt_pk_bf16_f32 v155, v98, v99
    v_mfma_f32_16x16x32_bf16 v[120:123], a[36:39], a[52:55], v[120:123]
    v_cvt_pk_bf16_f32 v172, v100, v101
    v_cvt_pk_bf16_f32 v173, v102, v103
    v_cvt_pk_bf16_f32 v156, v104, v105
    v_mfma_f32_16x16x32_bf16 v[124:127], a[40:43], a[52:55], v[124:127]
    v_cvt_pk_bf16_f32 v157, v106, v107
    v_cvt_pk_bf16_f32 v158, v108, v109
    v_cvt_pk_bf16_f32 v159, v110, v111
    v_mfma_f32_16x16x32_bf16 v[128:131], a[32:35], a[56:59], v[128:131]
    v_cvt_pk_bf16_f32 v176, v112, v113
    v_cvt_pk_bf16_f32 v177, v114, v115
    v_mfma_f32_16x16x32_bf16 v[132:135], a[36:39], a[56:59], v[132:135]
    v_mfma_f32_16x16x32_bf16 v[136:139], a[40:43], a[56:59], v[136:139]
    v_cvt_pk_bf16_f32 v160, v116, v117
    v_cvt_pk_bf16_f32 v161, v118, v119
    v_cvt_pk_bf16_f32 v162, v120, v121
    v_mfma_f32_16x16x32_bf16 v[140:143], a[32:35], a[60:63], v[140:143]
    v_cvt_pk_bf16_f32 v163, v122, v123
    v_cvt_pk_bf16_f32 v180, v124, v125
    v_cvt_pk_bf16_f32 v181, v126, v127
    v_mfma_f32_16x16x32_bf16 v[144:147], a[36:39], a[60:63], v[144:147]
    v_cvt_pk_bf16_f32 v164, v128, v129
    v_cvt_pk_bf16_f32 v165, v130, v131
    v_cvt_pk_bf16_f32 v166, v132, v133
    v_mfma_f32_16x16x32_bf16 v[148:151], a[40:43], a[60:63], v[148:151]
    v_cvt_pk_bf16_f32 v167, v134, v135
    v_cvt_pk_bf16_f32 v184, v136, v137
    v_cvt_pk_bf16_f32 v185, v138, v139
    s_waitcnt vmcnt(0)
    s_mov_b64 exec, 1
    s_cmp_lg_u64 s[56:57], 0
    s_cbranch_scc1 L_fg_26
    buffer_store_dword v84, v83, s[32:35], s64 offen
    s_branch L_fd_27
L_fg_26:
    buffer_store_dword v84, v83, s[32:35], s64 offen sc1
L_fd_27:
    s_mov_b64 exec, -1
    s_waitcnt lgkmcnt(10)
    v_mfma_f32_16x16x32_bf16 v[92:95], a[0:3], a[12:15], 0
    ds_read_b64_tr_b16 a[44:45], v6 offset:10240
    ds_read_b64_tr_b16 a[46:47], v6 offset:11520
    s_waitcnt lgkmcnt(11)
    v_mfma_f32_16x16x32_bf16 v[96:99], a[4:7], a[12:15], 0
    ds_read_b128 a[32:35], v5 offset:0
    ds_read_b128 a[36:39], v5 offset:2048
    s_waitcnt lgkmcnt(12)
    v_mfma_f32_16x16x32_bf16 v[100:103], a[8:11], a[12:15], 0
    ds_read_b128 a[40:43], v5 offset:4096
    ds_read_b64_tr_b16 a[48:49], v7 offset:10272
    s_waitcnt lgkmcnt(12)
    v_mfma_f32_16x16x32_bf16 v[104:107], a[0:3], a[16:19], 0
    ds_read_b64_tr_b16 a[50:51], v7 offset:11552
    ds_read_b64_tr_b16 a[52:53], v6 offset:10304
    v_mfma_f32_16x16x32_bf16 v[108:111], a[4:7], a[16:19], 0
    ds_read_b64_tr_b16 a[54:55], v6 offset:11584
    ds_read_b64_tr_b16 a[56:57], v7 offset:10336
    v_mfma_f32_16x16x32_bf16 v[112:115], a[8:11], a[16:19], 0
    ds_read_b64_tr_b16 a[58:59], v7 offset:11616
    ds_read_b64_tr_b16 a[60:61], v6 offset:10368
    s_waitcnt lgkmcnt(14)
    v_mfma_f32_16x16x32_bf16 v[116:119], a[0:3], a[20:23], 0
    ds_read_b64_tr_b16 a[62:63], v6 offset:11648
    v_cvt_pk_bf16_f32 v168, v140, v141
    v_mfma_f32_16x16x32_bf16 v[120:123], a[4:7], a[20:23], 0
    v_cvt_pk_bf16_f32 v169, v142, v143
    v_cvt_pk_bf16_f32 v170, v144, v145
    v_mfma_f32_16x16x32_bf16 v[124:127], a[8:11], a[20:23], 0
    v_cvt_pk_bf16_f32 v171, v146, v147
    v_cvt_pk_bf16_f32 v188, v148, v149
    v_mfma_f32_16x16x32_bf16 v[128:131], a[0:3], a[24:27], 0
    v_cvt_pk_bf16_f32 v189, v150, v151
    v_mfma_f32_16x16x32_bf16 v[132:135], a[4:7], a[24:27], 0
    v_mfma_f32_16x16x32_bf16 v[136:139], a[8:11], a[24:27], 0
    s_waitcnt lgkmcnt(13)
    v_mfma_f32_16x16x32_bf16 v[140:143], a[0:3], a[28:31], 0
    v_mfma_f32_16x16x32_bf16 v[144:147], a[4:7], a[28:31], 0
    v_mfma_f32_16x16x32_bf16 v[148:151], a[8:11], a[28:31], 0
    s_waitcnt lgkmcnt(0)
    s_barrier
    v_mfma_f32_16x16x32_bf16 v[92:95], a[32:35], a[44:47], v[92:95]
    v_add_u32 v4, 0xfffe8000, v4
    v_add_u32 v5, 0xfffe8000, v5
    v_mfma_f32_16x16x32_bf16 v[96:99], a[36:39], a[44:47], v[96:99]
    v_add_u32 v6, 0xfffe8000, v6
    v_add_u32 v7, 0xfffe8000, v7
    v_mfma_f32_16x16x32_bf16 v[100:103], a[40:43], a[44:47], v[100:103]
    ds_read_b64_tr_b16 a[12:13], v6 offset:0
    ds_read_b64_tr_b16 a[14:15], v6 offset:1280
    v_mfma_f32_16x16x32_bf16 v[104:107], a[32:35], a[48:51], v[104:107]
    ds_read_b128 a[0:3], v4 offset:0
    ds_read_b128 a[4:7], v4 offset:2048
    v_mfma_f32_16x16x32_bf16 v[108:111], a[36:39], a[48:51], v[108:111]
    ds_read_b128 a[8:11], v4 offset:4096
    ds_read_b64_tr_b16 a[16:17], v7 offset:32
    v_mfma_f32_16x16x32_bf16 v[112:115], a[40:43], a[48:51], v[112:115]
    ds_read_b64_tr_b16 a[18:19], v7 offset:1312
    ds_read_b64_tr_b16 a[20:21], v6 offset:64
    v_mfma_f32_16x16x32_bf16 v[116:119], a[32:35], a[52:55], v[116:119]
    ds_read_b64_tr_b16 a[22:23], v6 offset:1344
    ds_read_b64_tr_b16 a[24:25], v7 offset:96
    v_mfma_f32_16x16x32_bf16 v[120:123], a[36:39], a[52:55], v[120:123]
    ds_read_b64_tr_b16 a[26:27], v7 offset:1376
    ds_read_b64_tr_b16 a[28:29], v6 offset:128
    v_mfma_f32_16x16x32_bf16 v[124:127], a[40:43], a[52:55], v[124:127]
    ds_read_b64_tr_b16 a[30:31], v6 offset:1408
    ds_read_b128 v[8:11], v0 offset:0
    v_mfma_f32_16x16x32_bf16 v[128:131], a[32:35], a[56:59], v[128:131]
    ds_read_b128 v[12:15], v0 offset:1536
    ds_read_b128 v[16:19], v0 offset:3072
    v_mfma_f32_16x16x32_bf16 v[132:135], a[36:39], a[56:59], v[132:135]
    ds_read_b64 v[20:21], v1 offset:1024
    ds_read_b64 v[24:25], v1 offset:2560
    v_mfma_f32_16x16x32_bf16 v[136:139], a[40:43], a[56:59], v[136:139]
    ds_read_b64 v[28:29], v1 offset:4096
    v_mfma_f32_16x16x32_bf16 v[140:143], a[32:35], a[60:63], v[140:143]
    v_mfma_f32_16x16x32_bf16 v[144:147], a[36:39], a[60:63], v[144:147]
    v_mfma_f32_16x16x32_bf16 v[148:151], a[40:43], a[60:63], v[148:151]
    s_waitcnt lgkmcnt(5)
    v_mfma_f32_16x16x32_bf16 v[32:35], v[152:155], v[8:11], 0
    ds_read_b64_tr_b16 a[44:45], v6 offset:10240
    ds_read_b64_tr_b16 a[46:47], v6 offset:11520
    s_waitcnt lgkmcnt(6)
    v_mfma_f32_16x16x32_bf16 v[36:39], v[152:155], v[12:15], 0
    ds_read_b128 a[32:35], v5 offset:0
    ds_read_b128 a[36:39], v5 offset:2048
    s_waitcnt lgkmcnt(7)
    v_mfma_f32_16x16x32_bf16 v[40:43], v[152:155], v[16:19], 0
    ds_read_b128 a[40:43], v5 offset:4096
    ds_read_b64_tr_b16 a[48:49], v7 offset:10272
    v_mfma_f32_16x16x32_bf16 v[44:47], v[156:159], v[8:11], 0
    ds_read_b64_tr_b16 a[50:51], v7 offset:11552
    ds_read_b64_tr_b16 a[52:53], v6 offset:10304
    v_mfma_f32_16x16x32_bf16 v[48:51], v[156:159], v[12:15], 0
    ds_read_b64_tr_b16 a[54:55], v6 offset:11584
    ds_read_b64_tr_b16 a[56:57], v7 offset:10336
    v_mfma_f32_16x16x32_bf16 v[52:55], v[156:159], v[16:19], 0
    ds_read_b64_tr_b16 a[58:59], v7 offset:11616
    ds_read_b64_tr_b16 a[60:61], v6 offset:10368
    v_mfma_f32_16x16x32_bf16 v[56:59], v[160:163], v[8:11], 0
    ds_read_b64_tr_b16 a[62:63], v6 offset:11648
    v_mfma_f32_16x16x32_bf16 v[60:63], v[160:163], v[12:15], 0
    v_mfma_f32_16x16x32_bf16 v[64:67], v[160:163], v[16:19], 0
    v_mfma_f32_16x16x32_bf16 v[68:71], v[164:167], v[8:11], 0
    v_mfma_f32_16x16x32_bf16 v[72:75], v[164:167], v[12:15], 0
    v_mfma_f32_16x16x32_bf16 v[76:79], v[164:167], v[16:19], 0
    v_mfma_f32_16x16x32_bf16 v[80:83], v[168:171], v[8:11], 0
    v_mfma_f32_16x16x32_bf16 v[84:87], v[168:171], v[12:15], 0
    v_mfma_f32_16x16x32_bf16 v[88:91], v[168:171], v[16:19], 0
    v_mfma_f32_16x16x32_bf16 v[92:95], a[0:3], a[12:15], v[92:95]
    v_mfma_f32_16x16x32_bf16 v[96:99], a[4:7], a[12:15], v[96:99]
    v_mfma_f32_16x16x32_bf16 v[100:103], a[8:11], a[12:15], v[100:103]
    v_mfma_f32_16x16x32_bf16 v[104:107], a[0:3], a[16:19], v[104:107]
    v_mfma_f32_16x16x32_bf16 v[108:111], a[4:7], a[16:19], v[108:111]
    v_mfma_f32_16x16x32_bf16 v[112:115], a[8:11], a[16:19], v[112:115]
    v_mfma_f32_16x16x32_bf16 v[116:119], a[0:3], a[20:23], v[116:119]
    v_mfma_f32_16x16x32_bf16 v[120:123], a[4:7], a[20:23], v[120:123]
    v_mfma_f32_16x16x32_bf16 v[124:127], a[8:11], a[20:23], v[124:127]
    v_mfma_f32_16x16x32_bf16 v[128:131], a[0:3], a[24:27], v[128:131]
    v_mfma_f32_16x16x32_bf16 v[132:135], a[4:7], a[24:27], v[132:135]
    v_mfma_f32_16x16x32_bf16 v[136:139], a[8:11], a[24:27], v[136:139]
    v_mfma_f32_16x16x32_bf16 v[140:143], a[0:3], a[28:31], v[140:143]
    v_mfma_f32_16x16x32_bf16 v[144:147], a[4:7], a[28:31], v[144:147]
    v_mfma_f32_16x16x32_bf16 v[148:151], a[8:11], a[28:31], v[148:151]
    s_waitcnt lgkmcnt(0)
    s_barrier
    v_mfma_f32_16x16x32_bf16 v[92:95], a[32:35], a[44:47], v[92:95]
    v_add_u32 v4, 0x20000, v4
    v_add_u32 v5, 0x20000, v5
    v_add_u32 v6, 0x20000, v6
    v_mfma_f32_16x16x32_bf16 v[96:99], a[36:39], a[44:47], v[96:99]
    v_add_u32 v7, 0x20000, v7
    ds_read_b64_tr_b16 a[12:13], v6 offset:0
    ds_read_b64_tr_b16 a[14:15], v6 offset:1280
    v_mfma_f32_16x16x32_bf16 v[100:103], a[40:43], a[44:47], v[100:103]
    ds_read_b128 a[0:3], v4 offset:0
    ds_read_b128 a[4:7], v4 offset:2048
    ds_read_b128 a[8:11], v4 offset:4096
    v_mfma_f32_16x16x32_bf16 v[104:107], a[32:35], a[48:51], v[104:107]
    ds_read_b64_tr_b16 a[16:17], v7 offset:32
    ds_read_b64_tr_b16 a[18:19], v7 offset:1312
    ds_read_b64_tr_b16 a[20:21], v6 offset:64
    v_mfma_f32_16x16x32_bf16 v[108:111], a[36:39], a[48:51], v[108:111]
    ds_read_b64_tr_b16 a[22:23], v6 offset:1344
    ds_read_b64_tr_b16 a[24:25], v7 offset:96
    ds_read_b64_tr_b16 a[26:27], v7 offset:1376
    v_mfma_f32_16x16x32_bf16 v[112:115], a[40:43], a[48:51], v[112:115]
    ds_read_b64_tr_b16 a[28:29], v6 offset:128
    ds_read_b64_tr_b16 a[30:31], v6 offset:1408
    v_cvt_pk_bf16_f32 v152, v92, v93
    v_mfma_f32_16x16x32_bf16 v[116:119], a[32:35], a[52:55], v[116:119]
    v_cvt_pk_bf16_f32 v153, v94, v95
    v_cvt_pk_bf16_f32 v154, v96, v97
    v_cvt_pk_bf16_f32 v155, v98, v99
    v_mfma_f32_16x16x32_bf16 v[120:123], a[36:39], a[52:55], v[120:123]
    v_cvt_pk_bf16_f32 v174, v100, v101
    v_cvt_pk_bf16_f32 v175, v102, v103
    v_cvt_pk_bf16_f32 v156, v104, v105
    v_mfma_f32_16x16x32_bf16 v[124:127], a[40:43], a[52:55], v[124:127]
    v_cvt_pk_bf16_f32 v157, v106, v107
    v_cvt_pk_bf16_f32 v158, v108, v109
    v_cvt_pk_bf16_f32 v159, v110, v111
    v_mfma_f32_16x16x32_bf16 v[128:131], a[32:35], a[56:59], v[128:131]
    v_cvt_pk_bf16_f32 v178, v112, v113
    v_cvt_pk_bf16_f32 v179, v114, v115
    v_mfma_f32_16x16x32_bf16 v[132:135], a[36:39], a[56:59], v[132:135]
    v_mfma_f32_16x16x32_bf16 v[136:139], a[40:43], a[56:59], v[136:139]
    v_cvt_pk_bf16_f32 v160, v116, v117
    v_cvt_pk_bf16_f32 v161, v118, v119
    v_cvt_pk_bf16_f32 v162, v120, v121
    v_mfma_f32_16x16x32_bf16 v[140:143], a[32:35], a[60:63], v[140:143]
    v_cvt_pk_bf16_f32 v163, v122, v123
    v_cvt_pk_bf16_f32 v182, v124, v125
    v_cvt_pk_bf16_f32 v183, v126, v127
    v_mfma_f32_16x16x32_bf16 v[144:147], a[36:39], a[60:63], v[144:147]
    v_cvt_pk_bf16_f32 v164, v128, v129
    v_cvt_pk_bf16_f32 v165, v130, v131
    v_cvt_pk_bf16_f32 v166, v132, v133
    v_mfma_f32_16x16x32_bf16 v[148:151], a[40:43], a[60:63], v[148:151]
    v_cvt_pk_bf16_f32 v167, v134, v135
    v_cvt_pk_bf16_f32 v186, v136, v137
    v_cvt_pk_bf16_f32 v187, v138, v139
    s_waitcnt lgkmcnt(10)
    v_mfma_f32_16x16x32_bf16 v[92:95], a[0:3], a[12:15], 0
    ds_read_b64_tr_b16 a[44:45], v6 offset:10240
    ds_read_b64_tr_b16 a[46:47], v6 offset:11520
    s_waitcnt lgkmcnt(11)
    v_mfma_f32_16x16x32_bf16 v[96:99], a[4:7], a[12:15], 0
    ds_read_b128 a[32:35], v5 offset:0
    ds_read_b128 a[36:39], v5 offset:2048
    s_waitcnt lgkmcnt(12)
    v_mfma_f32_16x16x32_bf16 v[100:103], a[8:11], a[12:15], 0
    ds_read_b128 a[40:43], v5 offset:4096
    ds_read_b64_tr_b16 a[48:49], v7 offset:10272
    s_waitcnt lgkmcnt(12)
    v_mfma_f32_16x16x32_bf16 v[104:107], a[0:3], a[16:19], 0
    ds_read_b64_tr_b16 a[50:51], v7 offset:11552
    ds_read_b64_tr_b16 a[52:53], v6 offset:10304
    v_mfma_f32_16x16x32_bf16 v[108:111], a[4:7], a[16:19], 0
    ds_read_b64_tr_b16 a[54:55], v6 offset:11584
    ds_read_b64_tr_b16 a[56:57], v7 offset:10336
    v_mfma_f32_16x16x32_bf16 v[112:115], a[8:11], a[16:19], 0
    ds_read_b64_tr_b16 a[58:59], v7 offset:11616
    ds_read_b64_tr_b16 a[60:61], v6 offset:10368
    s_waitcnt lgkmcnt(14)
    v_mfma_f32_16x16x32_bf16 v[116:119], a[0:3], a[20:23], 0
    ds_read_b64_tr_b16 a[62:63], v6 offset:11648
    v_cvt_pk_bf16_f32 v168, v140, v141
    v_mfma_f32_16x16x32_bf16 v[120:123], a[4:7], a[20:23], 0
    v_cvt_pk_bf16_f32 v169, v142, v143
    v_cvt_pk_bf16_f32 v170, v144, v145
    v_mfma_f32_16x16x32_bf16 v[124:127], a[8:11], a[20:23], 0
    v_cvt_pk_bf16_f32 v171, v146, v147
    v_cvt_pk_bf16_f32 v190, v148, v149
    v_mfma_f32_16x16x32_bf16 v[128:131], a[0:3], a[24:27], 0
    v_cvt_pk_bf16_f32 v191, v150, v151
    v_mfma_f32_16x16x32_bf16 v[132:135], a[4:7], a[24:27], 0
    v_mfma_f32_16x16x32_bf16 v[136:139], a[8:11], a[24:27], 0
    s_waitcnt lgkmcnt(13)
    v_mfma_f32_16x16x32_bf16 v[140:143], a[0:3], a[28:31], 0
    v_mfma_f32_16x16x32_bf16 v[144:147], a[4:7], a[28:31], 0
    v_mfma_f32_16x16x32_bf16 v[148:151], a[8:11], a[28:31], 0
    s_waitcnt lgkmcnt(0)
    s_barrier
    v_mfma_f32_16x16x32_bf16 v[92:95], a[32:35], a[44:47], v[92:95]
    v_add_u32 v4, 0xfffe8000, v4
    v_add_u32 v5, 0xfffe8000, v5
    v_mfma_f32_16x16x32_bf16 v[96:99], a[36:39], a[44:47], v[96:99]
    v_add_u32 v6, 0xfffe8000, v6
    v_add_u32 v7, 0xfffe8000, v7
    v_mfma_f32_16x16x32_bf16 v[100:103], a[40:43], a[44:47], v[100:103]
    ds_read_b64_tr_b16 a[12:13], v6 offset:0
    ds_read_b64_tr_b16 a[14:15], v6 offset:1280
    v_mfma_f32_16x16x32_bf16 v[104:107], a[32:35], a[48:51], v[104:107]
    ds_read_b128 a[0:3], v4 offset:0
    ds_read_b128 a[4:7], v4 offset:2048
    v_mfma_f32_16x16x32_bf16 v[108:111], a[36:39], a[48:51], v[108:111]
    ds_read_b128 a[8:11], v4 offset:4096
    ds_read_b64_tr_b16 a[16:17], v7 offset:32
    v_mfma_f32_16x16x32_bf16 v[112:115], a[40:43], a[48:51], v[112:115]
    ds_read_b64_tr_b16 a[18:19], v7 offset:1312
    ds_read_b64_tr_b16 a[20:21], v6 offset:64
    v_mfma_f32_16x16x32_bf16 v[116:119], a[32:35], a[52:55], v[116:119]
    ds_read_b64_tr_b16 a[22:23], v6 offset:1344
    ds_read_b64_tr_b16 a[24:25], v7 offset:96
    v_mfma_f32_16x16x32_bf16 v[120:123], a[36:39], a[52:55], v[120:123]
    ds_read_b64_tr_b16 a[26:27], v7 offset:1376
    ds_read_b64_tr_b16 a[28:29], v6 offset:128
    v_mfma_f32_16x16x32_bf16 v[124:127], a[40:43], a[52:55], v[124:127]
    ds_read_b64_tr_b16 a[30:31], v6 offset:1408
    ds_read_b128 v[8:11], v0 offset:9216
    v_mfma_f32_16x16x32_bf16 v[128:131], a[32:35], a[56:59], v[128:131]
    ds_read_b128 v[12:15], v0 offset:10752
    ds_read_b128 v[16:19], v0 offset:12288
    v_mfma_f32_16x16x32_bf16 v[132:135], a[36:39], a[56:59], v[132:135]
    ds_read_b64 v[22:23], v1 offset:10240
    ds_read_b64 v[26:27], v1 offset:11776
    v_mfma_f32_16x16x32_bf16 v[136:139], a[40:43], a[56:59], v[136:139]
    ds_read_b64 v[30:31], v1 offset:13312
    v_mfma_f32_16x16x32_bf16 v[140:143], a[32:35], a[60:63], v[140:143]
    v_mfma_f32_16x16x32_bf16 v[144:147], a[36:39], a[60:63], v[144:147]
    v_mfma_f32_16x16x32_bf16 v[148:151], a[40:43], a[60:63], v[148:151]
    s_waitcnt lgkmcnt(5)
    v_mfma_f32_16x16x32_bf16 v[32:35], v[152:155], v[8:11], v[32:35]
    ds_read_b64_tr_b16 a[44:45], v6 offset:10240
    ds_read_b64_tr_b16 a[46:47], v6 offset:11520
    s_waitcnt lgkmcnt(6)
    v_mfma_f32_16x16x32_bf16 v[36:39], v[152:155], v[12:15], v[36:39]
    ds_read_b128 a[32:35], v5 offset:0
    ds_read_b128 a[36:39], v5 offset:2048
    s_waitcnt lgkmcnt(7)
    v_mfma_f32_16x16x32_bf16 v[40:43], v[152:155], v[16:19], v[40:43]
    ds_read_b128 a[40:43], v5 offset:4096
    ds_read_b64_tr_b16 a[48:49], v7 offset:10272
    v_mfma_f32_16x16x32_bf16 v[44:47], v[156:159], v[8:11], v[44:47]
    ds_read_b64_tr_b16 a[50:51], v7 offset:11552
    ds_read_b64_tr_b16 a[52:53], v6 offset:10304
    v_mfma_f32_16x16x32_bf16 v[48:51], v[156:159], v[12:15], v[48:51]
    ds_read_b64_tr_b16 a[54:55], v6 offset:11584
    ds_read_b64_tr_b16 a[56:57], v7 offset:10336
    v_mfma_f32_16x16x32_bf16 v[52:55], v[156:159], v[16:19], v[52:55]
    ds_read_b64_tr_b16 a[58:59], v7 offset:11616
    ds_read_b64_tr_b16 a[60:61], v6 offset:10368
    v_mfma_f32_16x16x32_bf16 v[56:59], v[160:163], v[8:11], v[56:59]
    ds_read_b64_tr_b16 a[62:63], v6 offset:11648
    v_mfma_f32_16x16x32_bf16 v[60:63], v[160:163], v[12:15], v[60:63]
    v_mfma_f32_16x16x32_bf16 v[64:67], v[160:163], v[16:19], v[64:67]
    v_mfma_f32_16x16x32_bf16 v[68:71], v[164:167], v[8:11], v[68:71]
    v_mfma_f32_16x16x32_bf16 v[72:75], v[164:167], v[12:15], v[72:75]
    v_mfma_f32_16x16x32_bf16 v[76:79], v[164:167], v[16:19], v[76:79]
    v_mfma_f32_16x16x32_bf16 v[80:83], v[168:171], v[8:11], v[80:83]
    v_mfma_f32_16x16x32_bf16 v[84:87], v[168:171], v[12:15], v[84:87]
    v_mfma_f32_16x16x32_bf16 v[88:91], v[168:171], v[16:19], v[88:91]
    s_waitcnt lgkmcnt(14)
    v_mfma_f32_16x16x32_bf16 v[32:35], v[172:175], v[20:23], v[32:35]
    v_mfma_f32_16x16x32_bf16 v[36:39], v[172:175], v[24:27], v[36:39]
    s_waitcnt lgkmcnt(13)
    v_mfma_f32_16x16x32_bf16 v[40:43], v[172:175], v[28:31], v[40:43]
    v_mfma_f32_16x16x32_bf16 v[44:47], v[176:179], v[20:23], v[44:47]
    v_mfma_f32_16x16x32_bf16 v[48:51], v[176:179], v[24:27], v[48:51]
    v_mfma_f32_16x16x32_bf16 v[52:55], v[176:179], v[28:31], v[52:55]
    v_mfma_f32_16x16x32_bf16 v[56:59], v[180:183], v[20:23], v[56:59]
    v_mfma_f32_16x16x32_bf16 v[60:63], v[180:183], v[24:27], v[60:63]
    v_mfma_f32_16x16x32_bf16 v[64:67], v[180:183], v[28:31], v[64:67]
    v_mfma_f32_16x16x32_bf16 v[68:71], v[184:187], v[20:23], v[68:71]
    v_mfma_f32_16x16x32_bf16 v[72:75], v[184:187], v[24:27], v[72:75]
    v_mfma_f32_16x16x32_bf16 v[76:79], v[184:187], v[28:31], v[76:79]
    v_mfma_f32_16x16x32_bf16 v[80:83], v[188:191], v[20:23], v[80:83]
    v_mfma_f32_16x16x32_bf16 v[84:87], v[188:191], v[24:27], v[84:87]
    v_mfma_f32_16x16x32_bf16 v[88:91], v[188:191], v[28:31], v[88:91]
    v_mfma_f32_16x16x32_bf16 v[92:95], a[0:3], a[12:15], v[92:95]
    v_mfma_f32_16x16x32_bf16 v[96:99], a[4:7], a[12:15], v[96:99]
    v_mfma_f32_16x16x32_bf16 v[100:103], a[8:11], a[12:15], v[100:103]
    v_mfma_f32_16x16x32_bf16 v[104:107], a[0:3], a[16:19], v[104:107]
    v_mfma_f32_16x16x32_bf16 v[108:111], a[4:7], a[16:19], v[108:111]
    v_mfma_f32_16x16x32_bf16 v[112:115], a[8:11], a[16:19], v[112:115]
    v_mfma_f32_16x16x32_bf16 v[116:119], a[0:3], a[20:23], v[116:119]
    v_mfma_f32_16x16x32_bf16 v[120:123], a[4:7], a[20:23], v[120:123]
    v_mfma_f32_16x16x32_bf16 v[124:127], a[8:11], a[20:23], v[124:127]
    v_mfma_f32_16x16x32_bf16 v[128:131], a[0:3], a[24:27], v[128:131]
    v_mfma_f32_16x16x32_bf16 v[132:135], a[4:7], a[24:27], v[132:135]
    v_mfma_f32_16x16x32_bf16 v[136:139], a[8:11], a[24:27], v[136:139]
    v_mfma_f32_16x16x32_bf16 v[140:143], a[0:3], a[28:31], v[140:143]
    v_mfma_f32_16x16x32_bf16 v[144:147], a[4:7], a[28:31], v[144:147]
    v_mfma_f32_16x16x32_bf16 v[148:151], a[8:11], a[28:31], v[148:151]
    s_waitcnt lgkmcnt(0)
    s_barrier
    v_mfma_f32_16x16x32_bf16 v[92:95], a[32:35], a[44:47], v[92:95]
    v_add_u32 v4, 0x10000, v4
    v_add_u32 v5, 0x10000, v5
    v_add_u32 v6, 0x10000, v6
    v_mfma_f32_16x16x32_bf16 v[96:99], a[36:39], a[44:47], v[96:99]
    v_add_u32 v7, 0x10000, v7
    ds_read_b64_tr_b16 a[12:13], v6 offset:0
    ds_read_b64_tr_b16 a[14:15], v6 offset:1280
    v_mfma_f32_16x16x32_bf16 v[100:103], a[40:43], a[44:47], v[100:103]
    ds_read_b128 a[0:3], v4 offset:0
    ds_read_b128 a[4:7], v4 offset:2048
    ds_read_b128 a[8:11], v4 offset:4096
    v_mfma_f32_16x16x32_bf16 v[104:107], a[32:35], a[48:51], v[104:107]
    ds_read_b64_tr_b16 a[16:17], v7 offset:32
    ds_read_b64_tr_b16 a[18:19], v7 offset:1312
    ds_read_b64_tr_b16 a[20:21], v6 offset:64
    v_mfma_f32_16x16x32_bf16 v[108:111], a[36:39], a[48:51], v[108:111]
    ds_read_b64_tr_b16 a[22:23], v6 offset:1344
    ds_read_b64_tr_b16 a[24:25], v7 offset:96
    ds_read_b64_tr_b16 a[26:27], v7 offset:1376
    v_mfma_f32_16x16x32_bf16 v[112:115], a[40:43], a[48:51], v[112:115]
    ds_read_b64_tr_b16 a[28:29], v6 offset:128
    ds_read_b64_tr_b16 a[30:31], v6 offset:1408
    v_cvt_pk_bf16_f32 v152, v92, v93
    v_mfma_f32_16x16x32_bf16 v[116:119], a[32:35], a[52:55], v[116:119]
    v_cvt_pk_bf16_f32 v153, v94, v95
    v_cvt_pk_bf16_f32 v154, v96, v97
    v_cvt_pk_bf16_f32 v155, v98, v99
    v_mfma_f32_16x16x32_bf16 v[120:123], a[36:39], a[52:55], v[120:123]
    v_cvt_pk_bf16_f32 v172, v100, v101
    v_cvt_pk_bf16_f32 v173, v102, v103
    v_cvt_pk_bf16_f32 v156, v104, v105
    v_mfma_f32_16x16x32_bf16 v[124:127], a[40:43], a[52:55], v[124:127]
    v_cvt_pk_bf16_f32 v157, v106, v107
    v_cvt_pk_bf16_f32 v158, v108, v109
    v_cvt_pk_bf16_f32 v159, v110, v111
    v_mfma_f32_16x16x32_bf16 v[128:131], a[32:35], a[56:59], v[128:131]
    v_cvt_pk_bf16_f32 v176, v112, v113
    v_cvt_pk_bf16_f32 v177, v114, v115
    v_mfma_f32_16x16x32_bf16 v[132:135], a[36:39], a[56:59], v[132:135]
    v_mfma_f32_16x16x32_bf16 v[136:139], a[40:43], a[56:59], v[136:139]
    v_cvt_pk_bf16_f32 v160, v116, v117
    v_cvt_pk_bf16_f32 v161, v118, v119
    v_cvt_pk_bf16_f32 v162, v120, v121
    v_mfma_f32_16x16x32_bf16 v[140:143], a[32:35], a[60:63], v[140:143]
    v_cvt_pk_bf16_f32 v163, v122, v123
    v_cvt_pk_bf16_f32 v180, v124, v125
    v_cvt_pk_bf16_f32 v181, v126, v127
    v_mfma_f32_16x16x32_bf16 v[144:147], a[36:39], a[60:63], v[144:147]
    v_cvt_pk_bf16_f32 v164, v128, v129
    v_cvt_pk_bf16_f32 v165, v130, v131
    v_cvt_pk_bf16_f32 v166, v132, v133
    v_mfma_f32_16x16x32_bf16 v[148:151], a[40:43], a[60:63], v[148:151]
    v_cvt_pk_bf16_f32 v167, v134, v135
    v_cvt_pk_bf16_f32 v184, v136, v137
    v_cvt_pk_bf16_f32 v185, v138, v139
    s_waitcnt lgkmcnt(10)
    v_mfma_f32_16x16x32_bf16 v[92:95], a[0:3], a[12:15], 0
    ds_read_b64_tr_b16 a[44:45], v6 offset:10240
    ds_read_b64_tr_b16 a[46:47], v6 offset:11520
    s_waitcnt lgkmcnt(11)
    v_mfma_f32_16x16x32_bf16 v[96:99], a[4:7], a[12:15], 0
    ds_read_b128 a[32:35], v5 offset:0
    ds_read_b128 a[36:39], v5 offset:2048
    s_waitcnt lgkmcnt(12)
    v_mfma_f32_16x16x32_bf16 v[100:103], a[8:11], a[12:15], 0
    ds_read_b128 a[40:43], v5 offset:4096
    ds_read_b64_tr_b16 a[48:49], v7 offset:10272
    s_waitcnt lgkmcnt(12)
    v_mfma_f32_16x16x32_bf16 v[104:107], a[0:3], a[16:19], 0
    ds_read_b64_tr_b16 a[50:51], v7 offset:11552
    ds_read_b64_tr_b16 a[52:53], v6 offset:10304
    v_mfma_f32_16x16x32_bf16 v[108:111], a[4:7], a[16:19], 0
    ds_read_b64_tr_b16 a[54:55], v6 offset:11584
    ds_read_b64_tr_b16 a[56:57], v7 offset:10336
    v_mfma_f32_16x16x32_bf16 v[112:115], a[8:11], a[16:19], 0
    ds_read_b64_tr_b16 a[58:59], v7 offset:11616
    ds_read_b64_tr_b16 a[60:61], v6 offset:10368
    s_waitcnt lgkmcnt(14)
    v_mfma_f32_16x16x32_bf16 v[116:119], a[0:3], a[20:23], 0
    ds_read_b64_tr_b16 a[62:63], v6 offset:11648
    v_cvt_pk_bf16_f32 v168, v140, v141
    v_mfma_f32_16x16x32_bf16 v[120:123], a[4:7], a[20:23], 0
    v_cvt_pk_bf16_f32 v169, v142, v143
    v_cvt_pk_bf16_f32 v170, v144, v145
    v_mfma_f32_16x16x32_bf16 v[124:127], a[8:11], a[20:23], 0
    v_cvt_pk_bf16_f32 v171, v146, v147
    v_cvt_pk_bf16_f32 v188, v148, v149
    v_mfma_f32_16x16x32_bf16 v[128:131], a[0:3], a[24:27], 0
    v_cvt_pk_bf16_f32 v189, v150, v151
    v_mfma_f32_16x16x32_bf16 v[132:135], a[4:7], a[24:27], 0
    v_mfma_f32_16x16x32_bf16 v[136:139], a[8:11], a[24:27], 0
    s_waitcnt lgkmcnt(13)
    v_mfma_f32_16x16x32_bf16 v[140:143], a[0:3], a[28:31], 0
    v_mfma_f32_16x16x32_bf16 v[144:147], a[4:7], a[28:31], 0
    v_mfma_f32_16x16x32_bf16 v[148:151], a[8:11], a[28:31], 0
    s_waitcnt lgkmcnt(0)
    s_barrier
    v_mfma_f32_16x16x32_bf16 v[92:95], a[32:35], a[44:47], v[92:95]
    v_add_u32 v4, 0xfffe8000, v4
    v_add_u32 v5, 0xfffe8000, v5
    v_mfma_f32_16x16x32_bf16 v[96:99], a[36:39], a[44:47], v[96:99]
    v_add_u32 v6, 0xfffe8000, v6
    v_add_u32 v7, 0xfffe8000, v7
    v_mfma_f32_16x16x32_bf16 v[100:103], a[40:43], a[44:47], v[100:103]
    ds_read_b64_tr_b16 a[12:13], v6 offset:0
    ds_read_b64_tr_b16 a[14:15], v6 offset:1280
    v_mfma_f32_16x16x32_bf16 v[104:107], a[32:35], a[48:51], v[104:107]
    ds_read_b128 a[0:3], v4 offset:0
    ds_read_b128 a[4:7], v4 offset:2048
    v_mfma_f32_16x16x32_bf16 v[108:111], a[36:39], a[48:51], v[108:111]
    ds_read_b128 a[8:11], v4 offset:4096
    ds_read_b64_tr_b16 a[16:17], v7 offset:32
    v_mfma_f32_16x16x32_bf16 v[112:115], a[40:43], a[48:51], v[112:115]
    ds_read_b64_tr_b16 a[18:19], v7 offset:1312
    ds_read_b64_tr_b16 a[20:21], v6 offset:64
    v_mfma_f32_16x16x32_bf16 v[116:119], a[32:35], a[52:55], v[116:119]
    ds_read_b64_tr_b16 a[22:23], v6 offset:1344
    ds_read_b64_tr_b16 a[24:25], v7 offset:96
    v_mfma_f32_16x16x32_bf16 v[120:123], a[36:39], a[52:55], v[120:123]
    ds_read_b64_tr_b16 a[26:27], v7 offset:1376
    ds_read_b64_tr_b16 a[28:29], v6 offset:128
    v_mfma_f32_16x16x32_bf16 v[124:127], a[40:43], a[52:55], v[124:127]
    ds_read_b64_tr_b16 a[30:31], v6 offset:1408
    ds_read_b128 v[8:11], v0 offset:18432
    v_mfma_f32_16x16x32_bf16 v[128:131], a[32:35], a[56:59], v[128:131]
    ds_read_b128 v[12:15], v0 offset:19968
    ds_read_b128 v[16:19], v0 offset:21504
    v_mfma_f32_16x16x32_bf16 v[132:135], a[36:39], a[56:59], v[132:135]
    ds_read_b64 v[20:21], v1 offset:19456
    ds_read_b64 v[24:25], v1 offset:20992
    v_mfma_f32_16x16x32_bf16 v[136:139], a[40:43], a[56:59], v[136:139]
    ds_read_b64 v[28:29], v1 offset:22528
    v_mfma_f32_16x16x32_bf16 v[140:143], a[32:35], a[60:63], v[140:143]
    v_mfma_f32_16x16x32_bf16 v[144:147], a[36:39], a[60:63], v[144:147]
    v_mfma_f32_16x16x32_bf16 v[148:151], a[40:43], a[60:63], v[148:151]
    s_waitcnt lgkmcnt(5)
    v_mfma_f32_16x16x32_bf16 v[32:35], v[152:155], v[8:11], v[32:35]
    ds_read_b64_tr_b16 a[44:45], v6 offset:10240
    ds_read_b64_tr_b16 a[46:47], v6 offset:11520
    s_waitcnt lgkmcnt(6)
    v_mfma_f32_16x16x32_bf16 v[36:39], v[152:155], v[12:15], v[36:39]
    ds_read_b128 a[32:35], v5 offset:0
    ds_read_b128 a[36:39], v5 offset:2048
    s_waitcnt lgkmcnt(7)
    v_mfma_f32_16x16x32_bf16 v[40:43], v[152:155], v[16:19], v[40:43]
    ds_read_b128 a[40:43], v5 offset:4096
    ds_read_b64_tr_b16 a[48:49], v7 offset:10272
    v_mfma_f32_16x16x32_bf16 v[44:47], v[156:159], v[8:11], v[44:47]
    ds_read_b64_tr_b16 a[50:51], v7 offset:11552
    ds_read_b64_tr_b16 a[52:53], v6 offset:10304
    v_mfma_f32_16x16x32_bf16 v[48:51], v[156:159], v[12:15], v[48:51]
    ds_read_b64_tr_b16 a[54:55], v6 offset:11584
    ds_read_b64_tr_b16 a[56:57], v7 offset:10336
    v_mfma_f32_16x16x32_bf16 v[52:55], v[156:159], v[16:19], v[52:55]
    ds_read_b64_tr_b16 a[58:59], v7 offset:11616
    ds_read_b64_tr_b16 a[60:61], v6 offset:10368
    v_mfma_f32_16x16x32_bf16 v[56:59], v[160:163], v[8:11], v[56:59]
    ds_read_b64_tr_b16 a[62:63], v6 offset:11648
    v_mfma_f32_16x16x32_bf16 v[60:63], v[160:163], v[12:15], v[60:63]
    v_mfma_f32_16x16x32_bf16 v[64:67], v[160:163], v[16:19], v[64:67]
    v_mfma_f32_16x16x32_bf16 v[68:71], v[164:167], v[8:11], v[68:71]
    v_mfma_f32_16x16x32_bf16 v[72:75], v[164:167], v[12:15], v[72:75]
    v_mfma_f32_16x16x32_bf16 v[76:79], v[164:167], v[16:19], v[76:79]
    v_mfma_f32_16x16x32_bf16 v[80:83], v[168:171], v[8:11], v[80:83]
    v_mfma_f32_16x16x32_bf16 v[84:87], v[168:171], v[12:15], v[84:87]
    v_mfma_f32_16x16x32_bf16 v[88:91], v[168:171], v[16:19], v[88:91]
    v_mfma_f32_16x16x32_bf16 v[92:95], a[0:3], a[12:15], v[92:95]
    ds_read_b128 v[8:11], v0 offset:0
    ds_read_b128 v[12:15], v0 offset:1536
    v_mfma_f32_16x16x32_bf16 v[96:99], a[4:7], a[12:15], v[96:99]
    ds_read_b128 v[16:19], v0 offset:3072
    ds_read_b64 v[22:23], v1 offset:1024
    v_mfma_f32_16x16x32_bf16 v[100:103], a[8:11], a[12:15], v[100:103]
    ds_read_b64 v[26:27], v1 offset:2560
    ds_read_b64 v[30:31], v1 offset:4096
    v_mfma_f32_16x16x32_bf16 v[104:107], a[0:3], a[16:19], v[104:107]
    v_mfma_f32_16x16x32_bf16 v[108:111], a[4:7], a[16:19], v[108:111]
    v_mfma_f32_16x16x32_bf16 v[112:115], a[8:11], a[16:19], v[112:115]
    v_mfma_f32_16x16x32_bf16 v[116:119], a[0:3], a[20:23], v[116:119]
    v_mfma_f32_16x16x32_bf16 v[120:123], a[4:7], a[20:23], v[120:123]
    v_mfma_f32_16x16x32_bf16 v[124:127], a[8:11], a[20:23], v[124:127]
    v_mfma_f32_16x16x32_bf16 v[128:131], a[0:3], a[24:27], v[128:131]
    v_mfma_f32_16x16x32_bf16 v[132:135], a[4:7], a[24:27], v[132:135]
    v_mfma_f32_16x16x32_bf16 v[136:139], a[8:11], a[24:27], v[136:139]
    v_mfma_f32_16x16x32_bf16 v[140:143], a[0:3], a[28:31], v[140:143]
    v_mfma_f32_16x16x32_bf16 v[144:147], a[4:7], a[28:31], v[144:147]
    v_mfma_f32_16x16x32_bf16 v[148:151], a[8:11], a[28:31], v[148:151]
    s_waitcnt lgkmcnt(14)
    v_mfma_f32_16x16x32_bf16 v[92:95], a[32:35], a[44:47], v[92:95]
    v_mbcnt_lo_u32_b32 v7, -1, 0
    v_mbcnt_hi_u32_b32 v7, -1, v7
    v_bfe_u32 v5, v7, 2, 2
    v_mfma_f32_16x16x32_bf16 v[96:99], a[36:39], a[44:47], v[96:99]
    v_lshrrev_b32 v6, 4, v7
    v_lshl_add_u32 v5, v5, 2, v6
    v_and_b32 v6, 3, v7
    v_mfma_f32_16x16x32_bf16 v[100:103], a[40:43], a[44:47], v[100:103]
    v_lshlrev_b32 v6, 4, v6
    v_lshl_add_u32 v4, v5, 6, v6
    v_lshrrev_b32 v5, 1, v7
    s_waitcnt lgkmcnt(12)
    v_mfma_f32_16x16x32_bf16 v[104:107], a[32:35], a[48:51], v[104:107]
    v_and_b32 v6, 1, v7
    v_lshlrev_b32 v6, 7, v6
    v_lshl_add_u32 v5, v5, 9, v6
    v_mfma_f32_16x16x32_bf16 v[108:111], a[36:39], a[48:51], v[108:111]
    v_mov_b32 v6, s52
    v_cvt_pk_bf16_f32 v152, v92, v93
    v_cvt_pk_bf16_f32 v153, v94, v95
    v_mfma_f32_16x16x32_bf16 v[112:115], a[40:43], a[48:51], v[112:115]
    v_cvt_pk_bf16_f32 v154, v96, v97
    v_cvt_pk_bf16_f32 v155, v98, v99
    v_cvt_pk_bf16_f32 v174, v100, v101
    s_waitcnt lgkmcnt(10)
    v_mfma_f32_16x16x32_bf16 v[116:119], a[32:35], a[52:55], v[116:119]
    v_cvt_pk_bf16_f32 v175, v102, v103
    v_mfma_f32_16x16x32_bf16 v[120:123], a[36:39], a[52:55], v[120:123]
    v_mfma_f32_16x16x32_bf16 v[124:127], a[40:43], a[52:55], v[124:127]
    s_waitcnt lgkmcnt(8)
    v_mfma_f32_16x16x32_bf16 v[128:131], a[32:35], a[56:59], v[128:131]
    v_cvt_pk_bf16_f32 v156, v104, v105
    v_cvt_pk_bf16_f32 v157, v106, v107
    v_cvt_pk_bf16_f32 v158, v108, v109
    v_mfma_f32_16x16x32_bf16 v[132:135], a[36:39], a[56:59], v[132:135]
    v_cvt_pk_bf16_f32 v159, v110, v111
    v_cvt_pk_bf16_f32 v178, v112, v113
    v_cvt_pk_bf16_f32 v179, v114, v115
    v_mfma_f32_16x16x32_bf16 v[136:139], a[40:43], a[56:59], v[136:139]
    v_cvt_pk_bf16_f32 v160, v116, v117
    v_cvt_pk_bf16_f32 v161, v118, v119
    v_cvt_pk_bf16_f32 v162, v120, v121
    s_waitcnt lgkmcnt(6)
    v_mfma_f32_16x16x32_bf16 v[140:143], a[32:35], a[60:63], v[140:143]
    v_cvt_pk_bf16_f32 v163, v122, v123
    v_cvt_pk_bf16_f32 v182, v124, v125
    v_cvt_pk_bf16_f32 v183, v126, v127
    v_mfma_f32_16x16x32_bf16 v[144:147], a[36:39], a[60:63], v[144:147]
    v_cvt_pk_bf16_f32 v164, v128, v129
    v_cvt_pk_bf16_f32 v165, v130, v131
    v_cvt_pk_bf16_f32 v166, v132, v133
    v_mfma_f32_16x16x32_bf16 v[148:151], a[40:43], a[60:63], v[148:151]
    v_cvt_pk_bf16_f32 v167, v134, v135
    v_cvt_pk_bf16_f32 v186, v136, v137
    v_cvt_pk_bf16_f32 v187, v138, v139
    s_nop 1
    s_waitcnt lgkmcnt(5)
    v_mfma_f32_16x16x32_bf16 v[32:35], v[152:155], v[8:11], v[32:35]
    s_waitcnt lgkmcnt(4)
    v_mfma_f32_16x16x32_bf16 v[36:39], v[152:155], v[12:15], v[36:39]
    s_waitcnt lgkmcnt(3)
    v_mfma_f32_16x16x32_bf16 v[40:43], v[152:155], v[16:19], v[40:43]
    v_cvt_pk_bf16_f32 v168, v140, v141
    v_cvt_pk_bf16_f32 v169, v142, v143
    s_waitcnt lgkmcnt(2)
    v_mfma_f32_16x16x32_bf16 v[32:35], v[172:175], v[20:23], v[32:35]
    v_cvt_pk_bf16_f32 v170, v144, v145
    v_cvt_pk_bf16_f32 v171, v146, v147
    s_waitcnt lgkmcnt(1)
    v_mfma_f32_16x16x32_bf16 v[36:39], v[172:175], v[24:27], v[36:39]
    v_cvt_pk_bf16_f32 v190, v148, v149
    v_cvt_pk_bf16_f32 v191, v150, v151
    s_waitcnt lgkmcnt(0)
    v_mfma_f32_16x16x32_bf16 v[40:43], v[172:175], v[28:31], v[40:43]
    s_nop 1
    v_mfma_f32_16x16x32_bf16 v[44:47], v[156:159], v[8:11], v[44:47]
    v_cvt_pk_bf16_f32 v92, v32, v33
    v_cvt_pk_bf16_f32 v93, v34, v35
    v_mfma_f32_16x16x32_bf16 v[48:51], v[156:159], v[12:15], v[48:51]
    v_cvt_pk_bf16_f32 v94, v36, v37
    v_cvt_pk_bf16_f32 v95, v38, v39
    v_mfma_f32_16x16x32_bf16 v[52:55], v[156:159], v[16:19], v[52:55]
    buffer_store_dwordx4 v[92:95], v4, s[32:35], s65 offen offset:0 sc1
    v_cvt_pk_bf16_f32 v96, v40, v41
    v_mfma_f32_16x16x32_bf16 v[44:47], v[176:179], v[20:23], v[44:47]
    v_cvt_pk_bf16_f32 v97, v42, v43
    v_mfma_f32_16x16x32_bf16 v[48:51], v[176:179], v[24:27], v[48:51]
    v_mfma_f32_16x16x32_bf16 v[52:55], v[176:179], v[28:31], v[52:55]
    s_nop 1
    v_mfma_f32_16x16x32_bf16 v[56:59], v[160:163], v[8:11], v[56:59]
    v_mfma_f32_16x16x32_bf16 v[60:63], v[160:163], v[12:15], v[60:63]
    v_mfma_f32_16x16x32_bf16 v[64:67], v[160:163], v[16:19], v[64:67]
    v_cvt_pk_bf16_f32 v98, v44, v45
    v_cvt_pk_bf16_f32 v99, v46, v47
    v_mfma_f32_16x16x32_bf16 v[56:59], v[180:183], v[20:23], v[56:59]
    buffer_store_dwordx4 v[96:99], v4, s[32:35], s65 offen offset:1024 sc1
    v_cvt_pk_bf16_f32 v100, v48, v49
    v_mfma_f32_16x16x32_bf16 v[60:63], v[180:183], v[24:27], v[60:63]
    v_cvt_pk_bf16_f32 v101, v50, v51
    v_cvt_pk_bf16_f32 v102, v52, v53
    v_mfma_f32_16x16x32_bf16 v[64:67], v[180:183], v[28:31], v[64:67]
    v_cvt_pk_bf16_f32 v103, v54, v55
    buffer_store_dwordx4 v[100:103], v4, s[32:35], s65 offen offset:2048 sc1
    s_nop 1
    v_mfma_f32_16x16x32_bf16 v[68:71], v[164:167], v[8:11], v[68:71]
    v_cvt_pk_bf16_f32 v104, v56, v57
    v_cvt_pk_bf16_f32 v105, v58, v59
    v_mfma_f32_16x16x32_bf16 v[72:75], v[164:167], v[12:15], v[72:75]
    v_cvt_pk_bf16_f32 v106, v60, v61
    v_cvt_pk_bf16_f32 v107, v62, v63
    v_mfma_f32_16x16x32_bf16 v[76:79], v[164:167], v[16:19], v[76:79]
    buffer_store_dwordx4 v[104:107], v4, s[32:35], s65 offen offset:3072 sc1
    v_cvt_pk_bf16_f32 v108, v64, v65
    v_mfma_f32_16x16x32_bf16 v[68:71], v[184:187], v[20:23], v[68:71]
    v_cvt_pk_bf16_f32 v109, v66, v67
    v_mfma_f32_16x16x32_bf16 v[72:75], v[184:187], v[24:27], v[72:75]
    v_mfma_f32_16x16x32_bf16 v[76:79], v[184:187], v[28:31], v[76:79]
    s_nop 1
    v_mfma_f32_16x16x32_bf16 v[80:83], v[168:171], v[8:11], v[80:83]
    v_mfma_f32_16x16x32_bf16 v[84:87], v[168:171], v[12:15], v[84:87]
    v_mfma_f32_16x16x32_bf16 v[88:91], v[168:171], v[16:19], v[88:91]
    v_cvt_pk_bf16_f32 v110, v68, v69
    v_cvt_pk_bf16_f32 v111, v70, v71
    v_mfma_f32_16x16x32_bf16 v[80:83], v[188:191], v[20:23], v[80:83]
    buffer_store_dwordx4 v[108:111], v4, s[32:35], s66 offen offset:0 sc1
    v_cvt_pk_bf16_f32 v112, v72, v73
    v_mfma_f32_16x16x32_bf16 v[84:87], v[188:191], v[24:27], v[84:87]
    v_cvt_pk_bf16_f32 v113, v74, v75
    v_cvt_pk_bf16_f32 v114, v76, v77
    v_mfma_f32_16x16x32_bf16 v[88:91], v[188:191], v[28:31], v[88:91]
    v_cvt_pk_bf16_f32 v115, v78, v79
    buffer_store_dwordx4 v[112:115], v4, s[32:35], s66 offen offset:1024 sc1
    s_barrier
    v_cvt_pk_bf16_f32 v116, v80, v81
    v_cvt_pk_bf16_f32 v117, v82, v83
    v_cvt_pk_bf16_f32 v118, v84, v85
    v_cvt_pk_bf16_f32 v119, v86, v87
    buffer_store_dwordx4 v[116:119], v4, s[32:35], s66 offen offset:2048 sc1
    v_cvt_pk_bf16_f32 v120, v88, v89
    v_cvt_pk_bf16_f32 v121, v90, v91
    buffer_store_dwordx4 v[120:123], v4, s[32:35], s66 offen offset:3072 sc1
    s_mov_b64 exec, 0xff
    s_waitcnt vmcnt(0)
    buffer_store_dword v6, v5, s[32:35], s69 offen sc1
L_end:
    s_endpgm
.section .rodata,"a"
.p2align 6
.amdhsa_kernel standalone__mha_block_cached__near_ridge_kernel
  .amdhsa_next_free_vgpr 256
  .amdhsa_next_free_sgpr 102
  .amdhsa_accum_offset 192
  .amdhsa_group_segment_fixed_size 0
  .amdhsa_kernarg_size 64
  .amdhsa_user_sgpr_count 2
  .amdhsa_user_sgpr_kernarg_segment_ptr 1
  .amdhsa_system_sgpr_workgroup_id_x 1
.end_amdhsa_kernel
```
